```python
import torch

def _softmax(x, axis=-1):
    return torch.softmax(x, dim=axis)
def _gelu(x):
    return torch.nn.functional.gelu(x, approximate="tanh")
def _silu(x):
    return torch.nn.functional.silu(x)
def _sigmoid(x):
    return torch.sigmoid(x)
def _layernorm(x, axis=-1, eps=1e-5):
    m = x.mean(dim=axis, keepdim=True)
    v = x.var(dim=axis, keepdim=True, unbiased=False)
    return (x - m) / torch.sqrt(v + eps)
def _scatter_add(tgt, idx, src, axis=0):
    return tgt.clone().index_add_(axis, idx, src)
def _segment_sum(src, seg, n):
    out = torch.zeros((n,) + src.shape[1:], dtype=src.dtype)
    return out.index_add_(0, seg, src)
def _pad(x, pw):
    flat = tuple(v for pair in reversed(pw) for v in pair)
    return torch.nn.functional.pad(x, flat)

kernel_name = 'parallel_sum__mha_block__moe_arch_mod__prompt'

def setup_inputs():

    _w = (lambda a: (lambda t: t.to(torch.bfloat16) if t.is_floating_point() else t)(torch.as_tensor(a)))
    def _A_setup():
        B, S, D, H = 1, 2048, 1024, 32
        return {
            "x": _w((lambda *s: torch.randn(*s, dtype=torch.bfloat16) * 0.05)(B, S, D)),
            "wqkv": _w((lambda *s: torch.randn(*s, dtype=torch.bfloat16) * 0.05)(D, 3 * D)),
            "wo": _w((lambda *s: torch.randn(*s, dtype=torch.bfloat16) * 0.05)(D, D)),
        }
    _A_in = _A_setup()

    def _B_setup():
        B, S, D, F, C = 1, 2048, 1024, 3584, 1
        return {
            "x": _w((lambda *s: torch.randn(*s, dtype=torch.bfloat16) * 0.05)(B, S, D)),
            "w_r": _w((lambda *s: torch.randn(*s, dtype=torch.bfloat16) * 0.05)(D)),
            "w_gate": _w((lambda *s: torch.randn(*s, dtype=torch.bfloat16) * 0.05)(D, F)),
            "w_up": _w((lambda *s: torch.randn(*s, dtype=torch.bfloat16) * 0.05)(D, F)),
            "w_down": _w((lambda *s: torch.randn(*s, dtype=torch.bfloat16) * 0.05)(F, D)),
        }
    _B_in = _B_setup()

    return {
        "A_x": _A_in["x"],
        "A_wqkv": _A_in["wqkv"],
        "A_wo": _A_in["wo"],
        "B_x": _B_in["x"],
        "B_w_r": _B_in["w_r"],
        "B_w_gate": _B_in["w_gate"],
        "B_w_up": _B_in["w_up"],
        "B_w_down": _B_in["w_down"],
    }

def reference(A_x, A_wqkv, A_wo, B_x, B_w_r, B_w_gate, B_w_up, B_w_down):
    def _A_ref(x, wqkv, wo):
        B, S, D = x.shape
        H = 32
        Dh = D // H
        qkv = (lambda x, *d: x.permute(*d))((x @ wqkv).reshape(B, S, 3, H, Dh), 2, 0, 3, 1, 4)
        q, k, v = qkv[0], qkv[1], qkv[2]
        scores = torch.einsum("bhqd,bhkd->bhqk", q, k) * (Dh ** -0.5)
        p = _softmax(scores, axis=-1)
        o = torch.einsum("bhqk,bhkd->bhqd", p, v)
        return (lambda x, *d: x.permute(*d))(o, 0, 2, 1, 3).reshape(B, S, D) @ wo

    def _B_ref(x, w_r, w_gate, w_up, w_down):
        B, S, D = x.shape
        C = 1
        r = x @ w_r
        idx = torch.argsort(-r, axis=-1)[:, :C]
        idx_e = (lambda x, n, axis: torch.repeat_interleave(x, n, dim=axis))(idx.reshape(B, C, 1), D, axis=2)
        x_sel = (lambda x, i, axis: torch.take_along_dim(x, i, dim=axis))(x, idx_e, axis=1)
        g = _silu(x_sel @ w_gate)
        u = x_sel @ w_up
        y = (g * u) @ w_down
        r_sel = _sigmoid((lambda x, i, axis: torch.take_along_dim(x, i, dim=axis))(r, idx, axis=1))
        y = y * r_sel.reshape(B, C, 1)
        b_off = (torch.arange(B) * S).reshape(B, 1)
        flat_idx = (idx + b_off).reshape(B * C)
        zero = (x * 0.0).reshape(B * S, D)
        upd = _scatter_add(zero, flat_idx, y.reshape(B * C, D), axis=0)
        return x + upd.reshape(B, S, D)

    x = A_x
    xn = _layernorm(x, axis=-1)
    return x + _A_ref(xn, A_wqkv, A_wo) + _B_ref(xn, B_w_r, B_w_gate, B_w_up, B_w_down)
```

```asm
; @launch grid=(256,1,1) block=(512,1,1) lds=163840
.amdgcn_target "amdgcn-amd-amdhsa--gfx950"
.text
.globl parallel_sum__mha_block__moe_arch_mod__prompt_kernel
.p2align 8
.type parallel_sum__mha_block__moe_arch_mod__prompt_kernel,@function
parallel_sum__mha_block__moe_arch_mod__prompt_kernel:
    s_cmp_ge_u32 s2, 256
    s_cbranch_scc1 L_end
    s_load_dwordx4 s[4:7], s[0:1], 0
    s_load_dwordx2 s[20:21], s[0:1], 80
    s_load_dwordx2 s[8:9], s[0:1], 16
    s_load_dwordx8 s[12:19], s[0:1], 32
    s_load_dwordx2 s[10:11], s[0:1], 64
    v_lshrrev_b32 v2, 6, v0
    v_and_b32 v1, 63, v0
    v_readfirstlane_b32 s62, v2
    v_lshlrev_b32 v2, 4, v1
    s_lshr_b32 s70, s2, 3
    s_lshr_b32 s60, s70, 2
    s_and_b32 s71, s2, 1
    s_lshl_b32 s71, s71, 3
    s_add_u32 s60, s60, s71
    s_and_b32 s61, s70, 3
    s_and_b32 s71, s2, 6
    s_lshl_b32 s71, s71, 1
    s_add_u32 s61, s61, s71
    s_and_b32 s66, s70, 15
    s_lshr_b32 s65, s70, 4
    s_and_b32 s71, s2, 7
    s_lshr_b32 s72, s71, 0
    s_lshl_b32 s72, s72, 1
    s_add_u32 s65, s65, s72
    s_lshr_b32 s67, s62, 2
    s_and_b32 s68, s62, 3
    s_lshl_b32 s71, s65, 2
    s_add_u32 s68, s68, s71
    s_mov_b32 s64, 0xffff0000
    s_cmp_ge_u32 s62, 4
    s_cbranch_scc1 L_helper
    v_lshrrev_b32 v198, 4, v1
    v_and_b32 v199, 7, v1
    v_xor_b32 v199, v199, v198
    v_lshrrev_b32 v198, 3, v1
    v_lshlrev_b32 v198, 11, v198
    v_lshl_add_u32 v180, v199, 4, v198
    v_xor_b32 v181, 64, v180
    v_add_u32 v181, 15360, v181
    v_add_u32 v182, 30720, v180
    v_add_u32 v183, 30720, v181
    v_lshrrev_b32 v198, 3, v1
    v_mul_u32_u24 v198, 6144, v198
    v_bfe_u32 v199, v1, 4, 1
    v_lshlrev_b32 v199, 2, v199
    v_and_b32 v184, 7, v1
    v_xor_b32 v199, v199, v184
    v_lshl_add_u32 v184, v199, 4, v198
    v_xor_b32 v185, 32, v184
    v_add_u32 v189, 52224, v185
    v_add_u32 v188, 4096, v184
    v_add_u32 v187, 48128, v185
    v_add_u32 v186, 0, v184
    v_add_u32 v185, 48128, v185
    s_lshl_b32 s70, s60, 18
    s_lshl_b32 s75, s62, 16
    s_add_u32 s70, s70, s75
    s_mul_i32 s71, s62, 98304
    s_lshl_b32 s75, s61, 7
    s_add_u32 s71, s71, s75
    s_lshl_b32 s72, s62, 12
    s_mul_i32 s73, s62, 6144
    s_add_u32 s73, s73, 16384
    s_lshr_b32 s75, s60, 3
    s_lshl_b32 s79, s75, 10
    s_mul_i32 s80, s75, 3145728
    s_add_u32 s70, s70, s79
    s_add_u32 s71, s71, s80
    s_lshl_b32 s79, s79, 1
    s_lshl_b32 s80, s80, 1
    s_waitcnt lgkmcnt(0)
    s_mov_b32 s24, s4
    s_and_b32 s25, s5, 0xffff
    s_mov_b32 s26, 0x400000
    s_mov_b32 s27, 0x00020000
    s_mov_b32 s28, s6
    s_and_b32 s29, s7, 0xffff
    s_mov_b32 s30, 0x600000
    s_mov_b32 s31, 0x00020000
    s_add_u32 m0, s72, 0
    s_nop 0
    buffer_load_dwordx4 v180, s[24:27], s70 offen offset:0 lds
    buffer_load_dwordx4 v181, s[24:27], s70 offen offset:1024 lds
    buffer_load_dwordx4 v182, s[24:27], s70 offen offset:2048 lds
    buffer_load_dwordx4 v183, s[24:27], s70 offen offset:3072 lds
    s_add_u32 s70, s70, 128
    s_add_u32 m0, s73, 0
    s_nop 0
    buffer_load_dwordx4 v184, s[28:31], s71 offen offset:0 lds
    buffer_load_dwordx4 v185, s[28:31], s71 offen offset:1024 lds
    buffer_load_dwordx4 v186, s[28:31], s71 offen offset:2048 lds
    buffer_load_dwordx4 v187, s[28:31], s71 offen offset:3072 lds
    s_add_u32 m0, s73, 4096
    s_nop 0
    buffer_load_dwordx4 v188, s[28:31], s71 offen offset:0 lds
    buffer_load_dwordx4 v189, s[28:31], s71 offen offset:1024 lds
    s_add_u32 s71, s71, 393216
    s_mov_b32 s32, s20
    s_and_b32 s33, s21, 0xffff
    s_mov_b32 s34, 0x10000000
    s_mov_b32 s35, 0x00020000
    s_mov_b32 s40, s10
    s_and_b32 s41, s11, 0xffff
    s_mov_b32 s42, 0x400000
    s_mov_b32 s43, 0x00020000
    v_and_b32 v198, 15, v1
    v_bfe_u32 v199, v1, 1, 3
    v_lshrrev_b32 v194, 4, v1
    s_lshr_b32 s75, s62, 1
    s_lshl_b32 s75, s75, 13
    v_xor_b32 v199, v199, v194
    v_lshlrev_b32 v199, 4, v199
    v_lshl_add_u32 v198, v198, 7, s75
    v_xor_b32 v190, 0, v199
    v_add_u32 v190, v190, v198
    v_add_u32 v192, 81920, v190
    v_xor_b32 v191, 64, v199
    v_add_u32 v191, v191, v198
    v_add_u32 v193, 81920, v191
    v_lshrrev_b32 v194, 5, v1
    v_mul_u32_u24 v194, 6144, v194
    v_bfe_u32 v198, v1, 4, 1
    v_lshl_add_u32 v194, v198, 10, v194
    v_lshl_add_u32 v194, v198, 5, v194
    v_bfe_u32 v198, v1, 2, 2
    v_lshl_add_u32 v194, v198, 7, v194
    s_and_b32 s75, s62, 1
    v_bfe_u32 v198, v1, 3, 1
    v_xor_b32 v198, s75, v198
    v_lshl_add_u32 v194, v198, 6, v194
    v_and_b32 v198, 3, v1
    v_lshl_add_u32 v194, v198, 3, v194
    v_add_u32 v194, 16384, v194
    v_xor_b32 v195, 32, v194
    v_add_u32 v196, 81920, v194
    v_add_u32 v197, 81920, v195
    v_mov_b32 v4, 0
    v_mov_b32 v5, 0
    v_mov_b32 v6, 0
    v_mov_b32 v7, 0
    v_mov_b32 v8, 0
    v_mov_b32 v9, 0
    v_mov_b32 v10, 0
    v_mov_b32 v11, 0
    v_mov_b32 v12, 0
    v_mov_b32 v13, 0
    v_mov_b32 v14, 0
    v_mov_b32 v15, 0
    v_mov_b32 v16, 0
    v_mov_b32 v17, 0
    v_mov_b32 v18, 0
    v_mov_b32 v19, 0
    v_mov_b32 v20, 0
    v_mov_b32 v21, 0
    v_mov_b32 v22, 0
    v_mov_b32 v23, 0
    v_mov_b32 v24, 0
    v_mov_b32 v25, 0
    v_mov_b32 v26, 0
    v_mov_b32 v27, 0
    v_mov_b32 v28, 0
    v_mov_b32 v29, 0
    v_mov_b32 v30, 0
    v_mov_b32 v31, 0
    v_mov_b32 v32, 0
    v_mov_b32 v33, 0
    v_mov_b32 v34, 0
    v_mov_b32 v35, 0
    v_mov_b32 v36, 0
    v_mov_b32 v37, 0
    v_mov_b32 v38, 0
    v_mov_b32 v39, 0
    v_mov_b32 v40, 0
    v_mov_b32 v41, 0
    v_mov_b32 v42, 0
    v_mov_b32 v43, 0
    v_mov_b32 v44, 0
    v_mov_b32 v45, 0
    v_mov_b32 v46, 0
    v_mov_b32 v47, 0
    v_mov_b32 v48, 0
    v_mov_b32 v49, 0
    v_mov_b32 v50, 0
    v_mov_b32 v51, 0
    v_mov_b32 v52, 0
    v_mov_b32 v53, 0
    v_mov_b32 v54, 0
    v_mov_b32 v55, 0
    v_mov_b32 v56, 0
    v_mov_b32 v57, 0
    v_mov_b32 v58, 0
    v_mov_b32 v59, 0
    v_mov_b32 v60, 0
    v_mov_b32 v61, 0
    v_mov_b32 v62, 0
    v_mov_b32 v63, 0
    v_mov_b32 v64, 0
    v_mov_b32 v65, 0
    v_mov_b32 v66, 0
    v_mov_b32 v67, 0
    v_mov_b32 v68, 0
    v_mov_b32 v69, 0
    v_mov_b32 v70, 0
    v_mov_b32 v71, 0
    v_mov_b32 v72, 0
    v_mov_b32 v73, 0
    v_mov_b32 v74, 0
    v_mov_b32 v75, 0
    v_mov_b32 v76, 0
    v_mov_b32 v77, 0
    v_mov_b32 v78, 0
    v_mov_b32 v79, 0
    v_mov_b32 v80, 0
    v_mov_b32 v81, 0
    v_mov_b32 v82, 0
    v_mov_b32 v83, 0
    v_mov_b32 v84, 0
    v_mov_b32 v85, 0
    v_mov_b32 v86, 0
    v_mov_b32 v87, 0
    v_mov_b32 v88, 0
    v_mov_b32 v89, 0
    v_mov_b32 v90, 0
    v_mov_b32 v91, 0
    v_mov_b32 v92, 0
    v_mov_b32 v93, 0
    v_mov_b32 v94, 0
    v_mov_b32 v95, 0
    v_mov_b32 v96, 0
    v_mov_b32 v97, 0
    v_mov_b32 v98, 0
    v_mov_b32 v99, 0
    s_add_u32 m0, s73, 40960
    s_nop 0
    buffer_load_dwordx4 v184, s[28:31], s71 offen offset:0 lds
    buffer_load_dwordx4 v185, s[28:31], s71 offen offset:1024 lds
    buffer_load_dwordx4 v186, s[28:31], s71 offen offset:2048 lds
    buffer_load_dwordx4 v187, s[28:31], s71 offen offset:3072 lds
    s_add_u32 m0, s73, 45056
    s_nop 0
    buffer_load_dwordx4 v188, s[28:31], s71 offen offset:0 lds
    buffer_load_dwordx4 v189, s[28:31], s71 offen offset:1024 lds
    s_add_u32 s71, s71, 393216
    s_add_u32 m0, s72, 40960
    s_nop 0
    buffer_load_dwordx4 v180, s[24:27], s70 offen offset:0 lds
    buffer_load_dwordx4 v181, s[24:27], s70 offen offset:1024 lds
    buffer_load_dwordx4 v182, s[24:27], s70 offen offset:2048 lds
    buffer_load_dwordx4 v183, s[24:27], s70 offen offset:3072 lds
    s_add_u32 s70, s70, 128
    v_min_u32 v200, 47, v1
    v_lshlrev_b32 v200, 7, v200
    s_lshl_b32 s75, s2, 2
    s_add_u32 s75, s75, s62
    s_lshr_b32 s76, s75, 7
    s_lshl_b32 s76, s76, 6
    s_bfe_u32 s74, s75, 0x10006
    s_lshl_b32 s74, s74, 9
    s_add_u32 s76, s76, s74
    s_and_b32 s74, s75, 63
    s_add_u32 s76, s76, s74
    s_add_u32 s76, s76, 128
    s_mul_i32 s76, s76, 6144
    s_sub_u32 s75, s75, 0
    s_cmp_lt_u32 s75, 256
    s_cselect_b32 s76, s76, 0x7f000000
    buffer_load_dword v201, v200, s[28:31], s76 offen
    s_mov_b32 s74, 0
    s_waitcnt vmcnt(11)
    s_barrier
    v_min_u32 v200, 47, v1
    v_lshlrev_b32 v200, 7, v200
    s_lshl_b32 s75, s2, 2
    s_add_u32 s75, s75, s62
    s_lshr_b32 s76, s75, 7
    s_lshl_b32 s76, s76, 6
    s_bfe_u32 s74, s75, 0x10006
    s_lshl_b32 s74, s74, 9
    s_add_u32 s76, s76, s74
    s_and_b32 s74, s75, 63
    s_add_u32 s76, s76, s74
    s_add_u32 s76, s76, 128
    s_mul_i32 s76, s76, 6144
    s_sub_u32 s75, s75, 256
    s_cmp_lt_u32 s75, 512
    s_cselect_b32 s76, s76, 0x7f000000
    buffer_load_dword v201, v200, s[28:31], s76 offen
    s_mov_b32 s74, 0
    ds_read_b128 v[100:103], v190 offset:0
    ds_read_b64_tr_b16 v[116:117], v194 offset:0
    ds_read_b64_tr_b16 v[118:119], v194 offset:512
    ds_read_b128 v[104:107], v190 offset:2048
    ds_read_b128 v[108:111], v190 offset:4096
    ds_read_b128 v[112:115], v190 offset:6144
    ds_read_b64_tr_b16 v[120:121], v195 offset:0
    ds_read_b64_tr_b16 v[122:123], v195 offset:512
    ds_read_b64_tr_b16 v[124:125], v194 offset:2048
    ds_read_b64_tr_b16 v[126:127], v194 offset:2560
    ds_read_b64_tr_b16 v[128:129], v195 offset:2048
    ds_read_b64_tr_b16 v[130:131], v195 offset:2560
    ds_read_b64_tr_b16 v[132:133], v194 offset:4096
    ds_read_b64_tr_b16 v[134:135], v194 offset:4608
    ds_read_b64_tr_b16 v[136:137], v195 offset:4096
    ds_read_b64_tr_b16 v[138:139], v195 offset:4608
    s_add_u32 m0, s73, 81920
    s_nop 0
    buffer_load_dwordx4 v184, s[28:31], s71 offen offset:0 lds
    buffer_load_dwordx4 v185, s[28:31], s71 offen offset:1024 lds
.p2align 6
L_gemm:
    s_waitcnt lgkmcnt(4)
    v_mfma_f32_16x16x32_bf16 v[4:7], v[116:119], v[100:103], v[4:7]
    ds_read_b128 v[140:143], v191 offset:0
    v_mfma_f32_16x16x32_bf16 v[12:15], v[116:119], v[104:107], v[12:15]
    ds_read_b64_tr_b16 v[156:157], v194 offset:12288
    v_mfma_f32_16x16x32_bf16 v[20:23], v[116:119], v[108:111], v[20:23]
    ds_read_b64_tr_b16 v[158:159], v194 offset:12800
    v_mfma_f32_16x16x32_bf16 v[28:31], v[116:119], v[112:115], v[28:31]
    buffer_load_dwordx4 v186, s[28:31], s71 offen offset:2048 lds
    v_mfma_f32_16x16x32_bf16 v[8:11], v[120:123], v[100:103], v[8:11]
    ds_read_b128 v[144:147], v191 offset:2048
    v_mfma_f32_16x16x32_bf16 v[16:19], v[120:123], v[104:107], v[16:19]
    ds_read_b128 v[148:151], v191 offset:4096
    v_mfma_f32_16x16x32_bf16 v[24:27], v[120:123], v[108:111], v[24:27]
    buffer_load_dwordx4 v187, s[28:31], s71 offen offset:3072 lds
    v_mfma_f32_16x16x32_bf16 v[32:35], v[120:123], v[112:115], v[32:35]
    ds_read_b128 v[152:155], v191 offset:6144
    v_mfma_f32_16x16x32_bf16 v[36:39], v[124:127], v[100:103], v[36:39]
    ds_read_b64_tr_b16 v[160:161], v195 offset:12288
    v_mfma_f32_16x16x32_bf16 v[44:47], v[124:127], v[104:107], v[44:47]
    s_add_u32 m0, s73, 86016
    ds_read_b64_tr_b16 v[162:163], v195 offset:12800
    v_mfma_f32_16x16x32_bf16 v[52:55], v[124:127], v[108:111], v[52:55]
    buffer_load_dwordx4 v188, s[28:31], s71 offen offset:0 lds
    v_mfma_f32_16x16x32_bf16 v[60:63], v[124:127], v[112:115], v[60:63]
    ds_read_b64_tr_b16 v[164:165], v194 offset:14336
    v_mfma_f32_16x16x32_bf16 v[40:43], v[128:131], v[100:103], v[40:43]
    ds_read_b64_tr_b16 v[166:167], v194 offset:14848
    v_mfma_f32_16x16x32_bf16 v[48:51], v[128:131], v[104:107], v[48:51]
    buffer_load_dwordx4 v189, s[28:31], s71 offen offset:1024 lds
    v_mfma_f32_16x16x32_bf16 v[56:59], v[128:131], v[108:111], v[56:59]
    s_add_u32 s71, s71, 393216
    ds_read_b64_tr_b16 v[168:169], v195 offset:14336
    v_mfma_f32_16x16x32_bf16 v[64:67], v[128:131], v[112:115], v[64:67]
    s_waitcnt lgkmcnt(11)
    ds_read_b64_tr_b16 v[170:171], v195 offset:14848
    v_mfma_f32_16x16x32_bf16 v[68:71], v[100:103], v[132:135], v[68:71]
    s_add_u32 m0, s72, 81920
    ds_read_b64_tr_b16 v[172:173], v194 offset:16384
    v_mfma_f32_16x16x32_bf16 v[76:79], v[104:107], v[132:135], v[76:79]
    buffer_load_dwordx4 v180, s[24:27], s70 offen offset:0 lds
    v_mfma_f32_16x16x32_bf16 v[84:87], v[108:111], v[132:135], v[84:87]
    ds_read_b64_tr_b16 v[174:175], v194 offset:16896
    v_mfma_f32_16x16x32_bf16 v[92:95], v[112:115], v[132:135], v[92:95]
    ds_read_b64_tr_b16 v[176:177], v195 offset:16384
    v_mfma_f32_16x16x32_bf16 v[72:75], v[100:103], v[136:139], v[72:75]
    buffer_load_dwordx4 v181, s[24:27], s70 offen offset:1024 lds
    v_mfma_f32_16x16x32_bf16 v[80:83], v[104:107], v[136:139], v[80:83]
    ds_read_b64_tr_b16 v[178:179], v195 offset:16896
    v_mfma_f32_16x16x32_bf16 v[88:91], v[108:111], v[136:139], v[88:91]
    v_mfma_f32_16x16x32_bf16 v[96:99], v[112:115], v[136:139], v[96:99]
    s_waitcnt lgkmcnt(4)
    v_mfma_f32_16x16x32_bf16 v[4:7], v[156:159], v[140:143], v[4:7]
    buffer_load_dwordx4 v182, s[24:27], s70 offen offset:2048 lds
    v_mfma_f32_16x16x32_bf16 v[12:15], v[156:159], v[144:147], v[12:15]
    v_mfma_f32_16x16x32_bf16 v[20:23], v[156:159], v[148:151], v[20:23]
    buffer_load_dwordx4 v183, s[24:27], s70 offen offset:3072 lds
    v_mfma_f32_16x16x32_bf16 v[28:31], v[156:159], v[152:155], v[28:31]
    s_add_u32 s70, s70, 128
    v_mfma_f32_16x16x32_bf16 v[8:11], v[160:163], v[140:143], v[8:11]
    v_mfma_f32_16x16x32_bf16 v[16:19], v[160:163], v[144:147], v[16:19]
    s_waitcnt lgkmcnt(0)
    s_waitcnt vmcnt(10)
    s_barrier
    ds_read_b128 v[100:103], v190 offset:40960
    v_mfma_f32_16x16x32_bf16 v[24:27], v[160:163], v[148:151], v[24:27]
    ds_read_b64_tr_b16 v[116:117], v194 offset:40960
    v_mfma_f32_16x16x32_bf16 v[32:35], v[160:163], v[152:155], v[32:35]
    ds_read_b64_tr_b16 v[118:119], v194 offset:41472
    v_mfma_f32_16x16x32_bf16 v[36:39], v[164:167], v[140:143], v[36:39]
    ds_read_b128 v[104:107], v190 offset:43008
    v_mfma_f32_16x16x32_bf16 v[44:47], v[164:167], v[144:147], v[44:47]
    ds_read_b128 v[108:111], v190 offset:45056
    v_mfma_f32_16x16x32_bf16 v[52:55], v[164:167], v[148:151], v[52:55]
    s_add_u32 m0, s73, 0
    ds_read_b128 v[112:115], v190 offset:47104
    v_mfma_f32_16x16x32_bf16 v[60:63], v[164:167], v[152:155], v[60:63]
    buffer_load_dwordx4 v184, s[28:31], s71 offen offset:0 lds
    v_mfma_f32_16x16x32_bf16 v[40:43], v[168:171], v[140:143], v[40:43]
    ds_read_b64_tr_b16 v[120:121], v195 offset:40960
    v_mfma_f32_16x16x32_bf16 v[48:51], v[168:171], v[144:147], v[48:51]
    ds_read_b64_tr_b16 v[122:123], v195 offset:41472
    v_mfma_f32_16x16x32_bf16 v[56:59], v[168:171], v[148:151], v[56:59]
    ds_read_b64_tr_b16 v[124:125], v194 offset:43008
    v_mfma_f32_16x16x32_bf16 v[64:67], v[168:171], v[152:155], v[64:67]
    ds_read_b64_tr_b16 v[126:127], v194 offset:43520
    v_mfma_f32_16x16x32_bf16 v[68:71], v[140:143], v[172:175], v[68:71]
    ds_read_b64_tr_b16 v[128:129], v195 offset:43008
    v_mfma_f32_16x16x32_bf16 v[76:79], v[144:147], v[172:175], v[76:79]
    buffer_load_dwordx4 v185, s[28:31], s71 offen offset:1024 lds
    v_mfma_f32_16x16x32_bf16 v[84:87], v[148:151], v[172:175], v[84:87]
    ds_read_b64_tr_b16 v[130:131], v195 offset:43520
    v_mfma_f32_16x16x32_bf16 v[92:95], v[152:155], v[172:175], v[92:95]
    ds_read_b64_tr_b16 v[132:133], v194 offset:45056
    v_mfma_f32_16x16x32_bf16 v[72:75], v[140:143], v[176:179], v[72:75]
    ds_read_b64_tr_b16 v[134:135], v194 offset:45568
    v_mfma_f32_16x16x32_bf16 v[80:83], v[144:147], v[176:179], v[80:83]
    ds_read_b64_tr_b16 v[136:137], v195 offset:45056
    v_mfma_f32_16x16x32_bf16 v[88:91], v[148:151], v[176:179], v[88:91]
    ds_read_b64_tr_b16 v[138:139], v195 offset:45568
    v_mfma_f32_16x16x32_bf16 v[96:99], v[152:155], v[176:179], v[96:99]
    s_waitcnt lgkmcnt(4)
    v_mfma_f32_16x16x32_bf16 v[4:7], v[116:119], v[100:103], v[4:7]
    ds_read_b128 v[140:143], v191 offset:40960
    v_mfma_f32_16x16x32_bf16 v[12:15], v[116:119], v[104:107], v[12:15]
    ds_read_b64_tr_b16 v[156:157], v194 offset:53248
    v_mfma_f32_16x16x32_bf16 v[20:23], v[116:119], v[108:111], v[20:23]
    ds_read_b64_tr_b16 v[158:159], v194 offset:53760
    v_mfma_f32_16x16x32_bf16 v[28:31], v[116:119], v[112:115], v[28:31]
    buffer_load_dwordx4 v186, s[28:31], s71 offen offset:2048 lds
    v_mfma_f32_16x16x32_bf16 v[8:11], v[120:123], v[100:103], v[8:11]
    ds_read_b128 v[144:147], v191 offset:43008
    v_mfma_f32_16x16x32_bf16 v[16:19], v[120:123], v[104:107], v[16:19]
    ds_read_b128 v[148:151], v191 offset:45056
    v_mfma_f32_16x16x32_bf16 v[24:27], v[120:123], v[108:111], v[24:27]
    buffer_load_dwordx4 v187, s[28:31], s71 offen offset:3072 lds
    v_mfma_f32_16x16x32_bf16 v[32:35], v[120:123], v[112:115], v[32:35]
    ds_read_b128 v[152:155], v191 offset:47104
    v_mfma_f32_16x16x32_bf16 v[36:39], v[124:127], v[100:103], v[36:39]
    ds_read_b64_tr_b16 v[160:161], v195 offset:53248
    v_mfma_f32_16x16x32_bf16 v[44:47], v[124:127], v[104:107], v[44:47]
    s_add_u32 m0, s73, 4096
    ds_read_b64_tr_b16 v[162:163], v195 offset:53760
    v_mfma_f32_16x16x32_bf16 v[52:55], v[124:127], v[108:111], v[52:55]
    buffer_load_dwordx4 v188, s[28:31], s71 offen offset:0 lds
    v_mfma_f32_16x16x32_bf16 v[60:63], v[124:127], v[112:115], v[60:63]
    ds_read_b64_tr_b16 v[164:165], v194 offset:55296
    v_mfma_f32_16x16x32_bf16 v[40:43], v[128:131], v[100:103], v[40:43]
    ds_read_b64_tr_b16 v[166:167], v194 offset:55808
    v_mfma_f32_16x16x32_bf16 v[48:51], v[128:131], v[104:107], v[48:51]
    buffer_load_dwordx4 v189, s[28:31], s71 offen offset:1024 lds
    v_mfma_f32_16x16x32_bf16 v[56:59], v[128:131], v[108:111], v[56:59]
    s_add_u32 s71, s71, 393216
    ds_read_b64_tr_b16 v[168:169], v195 offset:55296
    v_mfma_f32_16x16x32_bf16 v[64:67], v[128:131], v[112:115], v[64:67]
    s_waitcnt lgkmcnt(11)
    ds_read_b64_tr_b16 v[170:171], v195 offset:55808
    v_mfma_f32_16x16x32_bf16 v[68:71], v[100:103], v[132:135], v[68:71]
    s_add_u32 m0, s72, 0
    ds_read_b64_tr_b16 v[172:173], v194 offset:57344
    v_mfma_f32_16x16x32_bf16 v[76:79], v[104:107], v[132:135], v[76:79]
    buffer_load_dwordx4 v180, s[24:27], s70 offen offset:0 lds
    v_mfma_f32_16x16x32_bf16 v[84:87], v[108:111], v[132:135], v[84:87]
    ds_read_b64_tr_b16 v[174:175], v194 offset:57856
    v_mfma_f32_16x16x32_bf16 v[92:95], v[112:115], v[132:135], v[92:95]
    ds_read_b64_tr_b16 v[176:177], v195 offset:57344
    v_mfma_f32_16x16x32_bf16 v[72:75], v[100:103], v[136:139], v[72:75]
    buffer_load_dwordx4 v181, s[24:27], s70 offen offset:1024 lds
    v_mfma_f32_16x16x32_bf16 v[80:83], v[104:107], v[136:139], v[80:83]
    ds_read_b64_tr_b16 v[178:179], v195 offset:57856
    v_mfma_f32_16x16x32_bf16 v[88:91], v[108:111], v[136:139], v[88:91]
    v_mfma_f32_16x16x32_bf16 v[96:99], v[112:115], v[136:139], v[96:99]
    s_waitcnt lgkmcnt(4)
    v_mfma_f32_16x16x32_bf16 v[4:7], v[156:159], v[140:143], v[4:7]
    buffer_load_dwordx4 v182, s[24:27], s70 offen offset:2048 lds
    v_mfma_f32_16x16x32_bf16 v[12:15], v[156:159], v[144:147], v[12:15]
    v_mfma_f32_16x16x32_bf16 v[20:23], v[156:159], v[148:151], v[20:23]
    buffer_load_dwordx4 v183, s[24:27], s70 offen offset:3072 lds
    v_mfma_f32_16x16x32_bf16 v[28:31], v[156:159], v[152:155], v[28:31]
    s_add_u32 s70, s70, 128
    v_mfma_f32_16x16x32_bf16 v[8:11], v[160:163], v[140:143], v[8:11]
    v_mfma_f32_16x16x32_bf16 v[16:19], v[160:163], v[144:147], v[16:19]
    s_waitcnt lgkmcnt(0)
    s_waitcnt vmcnt(10)
    s_barrier
    ds_read_b128 v[100:103], v192 offset:0
    v_mfma_f32_16x16x32_bf16 v[24:27], v[160:163], v[148:151], v[24:27]
    ds_read_b64_tr_b16 v[116:117], v196 offset:0
    v_mfma_f32_16x16x32_bf16 v[32:35], v[160:163], v[152:155], v[32:35]
    ds_read_b64_tr_b16 v[118:119], v196 offset:512
    v_mfma_f32_16x16x32_bf16 v[36:39], v[164:167], v[140:143], v[36:39]
    ds_read_b128 v[104:107], v192 offset:2048
    v_mfma_f32_16x16x32_bf16 v[44:47], v[164:167], v[144:147], v[44:47]
    ds_read_b128 v[108:111], v192 offset:4096
    v_mfma_f32_16x16x32_bf16 v[52:55], v[164:167], v[148:151], v[52:55]
    s_add_u32 m0, s73, 40960
    ds_read_b128 v[112:115], v192 offset:6144
    v_mfma_f32_16x16x32_bf16 v[60:63], v[164:167], v[152:155], v[60:63]
    buffer_load_dwordx4 v184, s[28:31], s71 offen offset:0 lds
    v_mfma_f32_16x16x32_bf16 v[40:43], v[168:171], v[140:143], v[40:43]
    ds_read_b64_tr_b16 v[120:121], v197 offset:0
    v_mfma_f32_16x16x32_bf16 v[48:51], v[168:171], v[144:147], v[48:51]
    ds_read_b64_tr_b16 v[122:123], v197 offset:512
    v_mfma_f32_16x16x32_bf16 v[56:59], v[168:171], v[148:151], v[56:59]
    ds_read_b64_tr_b16 v[124:125], v196 offset:2048
    v_mfma_f32_16x16x32_bf16 v[64:67], v[168:171], v[152:155], v[64:67]
    ds_read_b64_tr_b16 v[126:127], v196 offset:2560
    v_mfma_f32_16x16x32_bf16 v[68:71], v[140:143], v[172:175], v[68:71]
    ds_read_b64_tr_b16 v[128:129], v197 offset:2048
    v_mfma_f32_16x16x32_bf16 v[76:79], v[144:147], v[172:175], v[76:79]
    buffer_load_dwordx4 v185, s[28:31], s71 offen offset:1024 lds
    v_mfma_f32_16x16x32_bf16 v[84:87], v[148:151], v[172:175], v[84:87]
    ds_read_b64_tr_b16 v[130:131], v197 offset:2560
    v_mfma_f32_16x16x32_bf16 v[92:95], v[152:155], v[172:175], v[92:95]
    ds_read_b64_tr_b16 v[132:133], v196 offset:4096
    v_mfma_f32_16x16x32_bf16 v[72:75], v[140:143], v[176:179], v[72:75]
    ds_read_b64_tr_b16 v[134:135], v196 offset:4608
    v_mfma_f32_16x16x32_bf16 v[80:83], v[144:147], v[176:179], v[80:83]
    ds_read_b64_tr_b16 v[136:137], v197 offset:4096
    v_mfma_f32_16x16x32_bf16 v[88:91], v[148:151], v[176:179], v[88:91]
    ds_read_b64_tr_b16 v[138:139], v197 offset:4608
    v_mfma_f32_16x16x32_bf16 v[96:99], v[152:155], v[176:179], v[96:99]
    s_waitcnt lgkmcnt(4)
    v_mfma_f32_16x16x32_bf16 v[4:7], v[116:119], v[100:103], v[4:7]
    ds_read_b128 v[140:143], v193 offset:0
    v_mfma_f32_16x16x32_bf16 v[12:15], v[116:119], v[104:107], v[12:15]
    ds_read_b64_tr_b16 v[156:157], v196 offset:12288
    v_mfma_f32_16x16x32_bf16 v[20:23], v[116:119], v[108:111], v[20:23]
    ds_read_b64_tr_b16 v[158:159], v196 offset:12800
    v_mfma_f32_16x16x32_bf16 v[28:31], v[116:119], v[112:115], v[28:31]
    buffer_load_dwordx4 v186, s[28:31], s71 offen offset:2048 lds
    v_mfma_f32_16x16x32_bf16 v[8:11], v[120:123], v[100:103], v[8:11]
    ds_read_b128 v[144:147], v193 offset:2048
    v_mfma_f32_16x16x32_bf16 v[16:19], v[120:123], v[104:107], v[16:19]
    ds_read_b128 v[148:151], v193 offset:4096
    v_mfma_f32_16x16x32_bf16 v[24:27], v[120:123], v[108:111], v[24:27]
    buffer_load_dwordx4 v187, s[28:31], s71 offen offset:3072 lds
    v_mfma_f32_16x16x32_bf16 v[32:35], v[120:123], v[112:115], v[32:35]
    ds_read_b128 v[152:155], v193 offset:6144
    v_mfma_f32_16x16x32_bf16 v[36:39], v[124:127], v[100:103], v[36:39]
    ds_read_b64_tr_b16 v[160:161], v197 offset:12288
    v_mfma_f32_16x16x32_bf16 v[44:47], v[124:127], v[104:107], v[44:47]
    s_add_u32 m0, s73, 45056
    ds_read_b64_tr_b16 v[162:163], v197 offset:12800
    v_mfma_f32_16x16x32_bf16 v[52:55], v[124:127], v[108:111], v[52:55]
    buffer_load_dwordx4 v188, s[28:31], s71 offen offset:0 lds
    v_mfma_f32_16x16x32_bf16 v[60:63], v[124:127], v[112:115], v[60:63]
    ds_read_b64_tr_b16 v[164:165], v196 offset:14336
    v_mfma_f32_16x16x32_bf16 v[40:43], v[128:131], v[100:103], v[40:43]
    ds_read_b64_tr_b16 v[166:167], v196 offset:14848
    v_mfma_f32_16x16x32_bf16 v[48:51], v[128:131], v[104:107], v[48:51]
    buffer_load_dwordx4 v189, s[28:31], s71 offen offset:1024 lds
    v_mfma_f32_16x16x32_bf16 v[56:59], v[128:131], v[108:111], v[56:59]
    s_add_u32 s71, s71, 393216
    ds_read_b64_tr_b16 v[168:169], v197 offset:14336
    v_mfma_f32_16x16x32_bf16 v[64:67], v[128:131], v[112:115], v[64:67]
    s_waitcnt lgkmcnt(11)
    ds_read_b64_tr_b16 v[170:171], v197 offset:14848
    v_mfma_f32_16x16x32_bf16 v[68:71], v[100:103], v[132:135], v[68:71]
    s_add_u32 m0, s72, 40960
    ds_read_b64_tr_b16 v[172:173], v196 offset:16384
    v_mfma_f32_16x16x32_bf16 v[76:79], v[104:107], v[132:135], v[76:79]
    buffer_load_dwordx4 v180, s[24:27], s70 offen offset:0 lds
    v_mfma_f32_16x16x32_bf16 v[84:87], v[108:111], v[132:135], v[84:87]
    ds_read_b64_tr_b16 v[174:175], v196 offset:16896
    v_mfma_f32_16x16x32_bf16 v[92:95], v[112:115], v[132:135], v[92:95]
    ds_read_b64_tr_b16 v[176:177], v197 offset:16384
    v_mfma_f32_16x16x32_bf16 v[72:75], v[100:103], v[136:139], v[72:75]
    buffer_load_dwordx4 v181, s[24:27], s70 offen offset:1024 lds
    v_mfma_f32_16x16x32_bf16 v[80:83], v[104:107], v[136:139], v[80:83]
    ds_read_b64_tr_b16 v[178:179], v197 offset:16896
    v_mfma_f32_16x16x32_bf16 v[88:91], v[108:111], v[136:139], v[88:91]
    v_mfma_f32_16x16x32_bf16 v[96:99], v[112:115], v[136:139], v[96:99]
    s_waitcnt lgkmcnt(4)
    v_mfma_f32_16x16x32_bf16 v[4:7], v[156:159], v[140:143], v[4:7]
    buffer_load_dwordx4 v182, s[24:27], s70 offen offset:2048 lds
    v_mfma_f32_16x16x32_bf16 v[12:15], v[156:159], v[144:147], v[12:15]
    v_mfma_f32_16x16x32_bf16 v[20:23], v[156:159], v[148:151], v[20:23]
    buffer_load_dwordx4 v183, s[24:27], s70 offen offset:3072 lds
    v_mfma_f32_16x16x32_bf16 v[28:31], v[156:159], v[152:155], v[28:31]
    s_add_u32 s70, s70, 128
    v_mfma_f32_16x16x32_bf16 v[8:11], v[160:163], v[140:143], v[8:11]
    v_mfma_f32_16x16x32_bf16 v[16:19], v[160:163], v[144:147], v[16:19]
    s_waitcnt lgkmcnt(0)
    s_waitcnt vmcnt(10)
    s_barrier
    ds_read_b128 v[100:103], v190 offset:0
    v_mfma_f32_16x16x32_bf16 v[24:27], v[160:163], v[148:151], v[24:27]
    ds_read_b64_tr_b16 v[116:117], v194 offset:0
    v_mfma_f32_16x16x32_bf16 v[32:35], v[160:163], v[152:155], v[32:35]
    ds_read_b64_tr_b16 v[118:119], v194 offset:512
    v_mfma_f32_16x16x32_bf16 v[36:39], v[164:167], v[140:143], v[36:39]
    ds_read_b128 v[104:107], v190 offset:2048
    v_mfma_f32_16x16x32_bf16 v[44:47], v[164:167], v[144:147], v[44:47]
    ds_read_b128 v[108:111], v190 offset:4096
    v_mfma_f32_16x16x32_bf16 v[52:55], v[164:167], v[148:151], v[52:55]
    s_cmp_eq_u32 s74, 1
    s_cselect_b32 s75, s79, 0
    s_cselect_b32 s76, s80, 0
    s_sub_u32 s70, s70, s75
    s_sub_u32 s71, s71, s76
    s_add_u32 s74, s74, 1
    s_add_u32 m0, s73, 81920
    ds_read_b128 v[112:115], v190 offset:6144
    v_mfma_f32_16x16x32_bf16 v[60:63], v[164:167], v[152:155], v[60:63]
    buffer_load_dwordx4 v184, s[28:31], s71 offen offset:0 lds
    v_mfma_f32_16x16x32_bf16 v[40:43], v[168:171], v[140:143], v[40:43]
    ds_read_b64_tr_b16 v[120:121], v195 offset:0
    v_mfma_f32_16x16x32_bf16 v[48:51], v[168:171], v[144:147], v[48:51]
    ds_read_b64_tr_b16 v[122:123], v195 offset:512
    v_mfma_f32_16x16x32_bf16 v[56:59], v[168:171], v[148:151], v[56:59]
    ds_read_b64_tr_b16 v[124:125], v194 offset:2048
    v_mfma_f32_16x16x32_bf16 v[64:67], v[168:171], v[152:155], v[64:67]
    ds_read_b64_tr_b16 v[126:127], v194 offset:2560
    v_mfma_f32_16x16x32_bf16 v[68:71], v[140:143], v[172:175], v[68:71]
    ds_read_b64_tr_b16 v[128:129], v195 offset:2048
    v_mfma_f32_16x16x32_bf16 v[76:79], v[144:147], v[172:175], v[76:79]
    buffer_load_dwordx4 v185, s[28:31], s71 offen offset:1024 lds
    v_mfma_f32_16x16x32_bf16 v[84:87], v[148:151], v[172:175], v[84:87]
    s_cmp_lt_u32 s74, 4
    ds_read_b64_tr_b16 v[130:131], v195 offset:2560
    v_mfma_f32_16x16x32_bf16 v[92:95], v[152:155], v[172:175], v[92:95]
    ds_read_b64_tr_b16 v[132:133], v194 offset:4096
    v_mfma_f32_16x16x32_bf16 v[72:75], v[140:143], v[176:179], v[72:75]
    ds_read_b64_tr_b16 v[134:135], v194 offset:4608
    v_mfma_f32_16x16x32_bf16 v[80:83], v[144:147], v[176:179], v[80:83]
    ds_read_b64_tr_b16 v[136:137], v195 offset:4096
    v_mfma_f32_16x16x32_bf16 v[88:91], v[148:151], v[176:179], v[88:91]
    ds_read_b64_tr_b16 v[138:139], v195 offset:4608
    v_mfma_f32_16x16x32_bf16 v[96:99], v[152:155], v[176:179], v[96:99]
    s_cbranch_scc1 L_gemm
    s_waitcnt lgkmcnt(4)
    v_mfma_f32_16x16x32_bf16 v[4:7], v[116:119], v[100:103], v[4:7]
    ds_read_b128 v[140:143], v191 offset:0
    v_and_b32 v198, 48, v1
    v_mfma_f32_16x16x32_bf16 v[12:15], v[116:119], v[104:107], v[12:15]
    ds_read_b64_tr_b16 v[156:157], v194 offset:12288
    s_lshr_b32 s75, s62, 1
    v_mfma_f32_16x16x32_bf16 v[20:23], v[116:119], v[108:111], v[20:23]
    ds_read_b64_tr_b16 v[158:159], v194 offset:12800
    v_mfma_f32_16x16x32_bf16 v[28:31], v[116:119], v[112:115], v[28:31]
    buffer_load_dwordx4 v186, s[28:31], s71 offen offset:2048 lds
    s_lshl_b32 s75, s75, 8
    v_mfma_f32_16x16x32_bf16 v[8:11], v[120:123], v[100:103], v[8:11]
    ds_read_b128 v[144:147], v191 offset:2048
    v_mfma_f32_16x16x32_bf16 v[16:19], v[120:123], v[104:107], v[16:19]
    ds_read_b128 v[148:151], v191 offset:4096
    s_add_u32 s75, s75, 126976
    v_mfma_f32_16x16x32_bf16 v[24:27], v[120:123], v[108:111], v[24:27]
    buffer_load_dwordx4 v187, s[28:31], s71 offen offset:3072 lds
    v_mfma_f32_16x16x32_bf16 v[32:35], v[120:123], v[112:115], v[32:35]
    ds_read_b128 v[152:155], v191 offset:6144
    s_and_b32 s76, s62, 1
    v_mfma_f32_16x16x32_bf16 v[36:39], v[124:127], v[100:103], v[36:39]
    ds_read_b64_tr_b16 v[160:161], v195 offset:12288
    v_mfma_f32_16x16x32_bf16 v[44:47], v[124:127], v[104:107], v[44:47]
    s_add_u32 m0, s73, 86016
    ds_read_b64_tr_b16 v[162:163], v195 offset:12800
    s_lshl_b32 s76, s76, 7
    v_mfma_f32_16x16x32_bf16 v[52:55], v[124:127], v[108:111], v[52:55]
    buffer_load_dwordx4 v188, s[28:31], s71 offen offset:0 lds
    v_mfma_f32_16x16x32_bf16 v[60:63], v[124:127], v[112:115], v[60:63]
    ds_read_b64_tr_b16 v[164:165], v194 offset:14336
    s_add_u32 s76, s76, 128000
    v_mfma_f32_16x16x32_bf16 v[40:43], v[128:131], v[100:103], v[40:43]
    ds_read_b64_tr_b16 v[166:167], v194 offset:14848
    v_add_u32 v202, s76, v198
    v_mfma_f32_16x16x32_bf16 v[48:51], v[128:131], v[104:107], v[48:51]
    buffer_load_dwordx4 v189, s[28:31], s71 offen offset:1024 lds
    v_mfma_f32_16x16x32_bf16 v[56:59], v[128:131], v[108:111], v[56:59]
    s_add_u32 s71, s71, 393216
    ds_read_b64_tr_b16 v[168:169], v195 offset:14336
    v_add_u32 v198, s75, v198
    v_mfma_f32_16x16x32_bf16 v[64:67], v[128:131], v[112:115], v[64:67]
    s_waitcnt lgkmcnt(11)
    ds_read_b64_tr_b16 v[170:171], v195 offset:14848
    v_mfma_f32_16x16x32_bf16 v[68:71], v[100:103], v[132:135], v[68:71]
    s_add_u32 m0, s72, 81920
    ds_read_b64_tr_b16 v[172:173], v194 offset:16384
    v_and_b32 v199, 15, v1
    v_mfma_f32_16x16x32_bf16 v[76:79], v[104:107], v[132:135], v[76:79]
    buffer_load_dwordx4 v180, s[24:27], s70 offen offset:0 lds
    v_mfma_f32_16x16x32_bf16 v[84:87], v[108:111], v[132:135], v[84:87]
    ds_read_b64_tr_b16 v[174:175], v194 offset:16896
    v_lshlrev_b32 v199, 2, v199
    v_mfma_f32_16x16x32_bf16 v[92:95], v[112:115], v[132:135], v[92:95]
    ds_read_b64_tr_b16 v[176:177], v195 offset:16384
    v_mfma_f32_16x16x32_bf16 v[72:75], v[100:103], v[136:139], v[72:75]
    buffer_load_dwordx4 v181, s[24:27], s70 offen offset:1024 lds
    v_add_u32 v203, s76, v199
    v_mfma_f32_16x16x32_bf16 v[80:83], v[104:107], v[136:139], v[80:83]
    ds_read_b64_tr_b16 v[178:179], v195 offset:16896
    v_mfma_f32_16x16x32_bf16 v[88:91], v[108:111], v[136:139], v[88:91]
    v_add_u32 v199, s75, v199
    v_mfma_f32_16x16x32_bf16 v[96:99], v[112:115], v[136:139], v[96:99]
    s_waitcnt lgkmcnt(4)
    v_mfma_f32_16x16x32_bf16 v[4:7], v[156:159], v[140:143], v[4:7]
    buffer_load_dwordx4 v182, s[24:27], s70 offen offset:2048 lds
    v_mfma_f32_16x16x32_bf16 v[12:15], v[156:159], v[144:147], v[12:15]
    v_mfma_f32_16x16x32_bf16 v[20:23], v[156:159], v[148:151], v[20:23]
    buffer_load_dwordx4 v183, s[24:27], s70 offen offset:3072 lds
    v_mfma_f32_16x16x32_bf16 v[28:31], v[156:159], v[152:155], v[28:31]
    s_add_u32 s70, s70, 128
    v_mfma_f32_16x16x32_bf16 v[8:11], v[160:163], v[140:143], v[8:11]
    v_mfma_f32_16x16x32_bf16 v[16:19], v[160:163], v[144:147], v[16:19]
    s_waitcnt lgkmcnt(0)
    s_waitcnt vmcnt(10)
    s_barrier
    ds_read_b128 v[100:103], v190 offset:40960
    v_mfma_f32_16x16x32_bf16 v[24:27], v[160:163], v[148:151], v[24:27]
    ds_read_b64_tr_b16 v[124:125], v194 offset:43008
    v_mfma_f32_16x16x32_bf16 v[32:35], v[160:163], v[152:155], v[32:35]
    s_add_u32 m0, s73, 0
    ds_read_b64_tr_b16 v[126:127], v194 offset:43520
    v_mfma_f32_16x16x32_bf16 v[36:39], v[164:167], v[140:143], v[36:39]
    buffer_load_dwordx4 v184, s[28:31], s71 offen offset:0 lds
    v_mfma_f32_16x16x32_bf16 v[44:47], v[164:167], v[144:147], v[44:47]
    ds_read_b128 v[104:107], v190 offset:43008
    v_mfma_f32_16x16x32_bf16 v[52:55], v[164:167], v[148:151], v[52:55]
    ds_read_b128 v[108:111], v190 offset:45056
    v_mfma_f32_16x16x32_bf16 v[60:63], v[164:167], v[152:155], v[60:63]
    ds_read_b128 v[112:115], v190 offset:47104
    v_mfma_f32_16x16x32_bf16 v[40:43], v[168:171], v[140:143], v[40:43]
    buffer_load_dwordx4 v185, s[28:31], s71 offen offset:1024 lds
    v_mfma_f32_16x16x32_bf16 v[48:51], v[168:171], v[144:147], v[48:51]
    ds_read_b64_tr_b16 v[128:129], v195 offset:43008
    v_mfma_f32_16x16x32_bf16 v[56:59], v[168:171], v[148:151], v[56:59]
    ds_read_b64_tr_b16 v[130:131], v195 offset:43520
    v_mfma_f32_16x16x32_bf16 v[64:67], v[168:171], v[152:155], v[64:67]
    ds_read_b64_tr_b16 v[132:133], v194 offset:45056
    v_mfma_f32_16x16x32_bf16 v[68:71], v[140:143], v[172:175], v[68:71]
    buffer_load_dwordx4 v186, s[28:31], s71 offen offset:2048 lds
    v_mfma_f32_16x16x32_bf16 v[76:79], v[144:147], v[172:175], v[76:79]
    ds_read_b64_tr_b16 v[134:135], v194 offset:45568
    v_mfma_f32_16x16x32_bf16 v[84:87], v[148:151], v[172:175], v[84:87]
    ds_read_b64_tr_b16 v[136:137], v195 offset:45056
    v_mfma_f32_16x16x32_bf16 v[92:95], v[152:155], v[172:175], v[92:95]
    ds_read_b64_tr_b16 v[138:139], v195 offset:45568
    v_mfma_f32_16x16x32_bf16 v[72:75], v[140:143], v[176:179], v[72:75]
    buffer_load_dwordx4 v187, s[28:31], s71 offen offset:3072 lds
    v_mfma_f32_16x16x32_bf16 v[80:83], v[144:147], v[176:179], v[80:83]
    v_mfma_f32_16x16x32_bf16 v[88:91], v[148:151], v[176:179], v[88:91]
    v_mfma_f32_16x16x32_bf16 v[96:99], v[152:155], v[176:179], v[96:99]
    s_waitcnt lgkmcnt(4)
    v_mfma_f32_16x16x32_bf16 v[36:39], v[124:127], v[100:103], v[36:39]
    ds_read_b128 v[140:143], v191 offset:40960
    ds_read_b64_tr_b16 v[164:165], v194 offset:55296
    v_mfma_f32_16x16x32_bf16 v[44:47], v[124:127], v[104:107], v[44:47]
    ds_read_b64_tr_b16 v[166:167], v194 offset:55808
    v_mfma_f32_16x16x32_bf16 v[52:55], v[124:127], v[108:111], v[52:55]
    s_add_u32 m0, s73, 4096
    ds_read_b128 v[144:147], v191 offset:43008
    v_mfma_f32_16x16x32_bf16 v[60:63], v[124:127], v[112:115], v[60:63]
    buffer_load_dwordx4 v188, s[28:31], s71 offen offset:0 lds
    v_mfma_f32_16x16x32_bf16 v[40:43], v[128:131], v[100:103], v[40:43]
    ds_read_b128 v[148:151], v191 offset:45056
    v_mfma_f32_16x16x32_bf16 v[48:51], v[128:131], v[104:107], v[48:51]
    ds_read_b128 v[152:155], v191 offset:47104
    v_mfma_f32_16x16x32_bf16 v[56:59], v[128:131], v[108:111], v[56:59]
    buffer_load_dwordx4 v189, s[28:31], s71 offen offset:1024 lds
    v_mfma_f32_16x16x32_bf16 v[64:67], v[128:131], v[112:115], v[64:67]
    s_waitcnt lgkmcnt(6)
    s_add_u32 s71, s71, 393216
    ds_read_b64_tr_b16 v[168:169], v195 offset:55296
    v_mfma_f32_16x16x32_bf16 v[68:71], v[100:103], v[132:135], v[68:71]
    s_add_u32 m0, s72, 0
    ds_read_b64_tr_b16 v[170:171], v195 offset:55808
    v_mfma_f32_16x16x32_bf16 v[76:79], v[104:107], v[132:135], v[76:79]
    buffer_load_dwordx4 v180, s[24:27], s70 offen offset:0 lds
    v_mfma_f32_16x16x32_bf16 v[84:87], v[108:111], v[132:135], v[84:87]
    ds_read_b64_tr_b16 v[172:173], v194 offset:57344
    v_mfma_f32_16x16x32_bf16 v[92:95], v[112:115], v[132:135], v[92:95]
    ds_read_b64_tr_b16 v[174:175], v194 offset:57856
    v_mfma_f32_16x16x32_bf16 v[72:75], v[100:103], v[136:139], v[72:75]
    buffer_load_dwordx4 v181, s[24:27], s70 offen offset:1024 lds
    v_mfma_f32_16x16x32_bf16 v[80:83], v[104:107], v[136:139], v[80:83]
    ds_read_b64_tr_b16 v[176:177], v195 offset:57344
    v_mfma_f32_16x16x32_bf16 v[88:91], v[108:111], v[136:139], v[88:91]
    ds_read_b64_tr_b16 v[178:179], v195 offset:57856
    v_mfma_f32_16x16x32_bf16 v[96:99], v[112:115], v[136:139], v[96:99]
    s_waitcnt lgkmcnt(4)
    v_mfma_f32_16x16x32_bf16 v[36:39], v[164:167], v[140:143], v[36:39]
    buffer_load_dwordx4 v182, s[24:27], s70 offen offset:2048 lds
    v_mfma_f32_16x16x32_bf16 v[44:47], v[164:167], v[144:147], v[44:47]
    v_mfma_f32_16x16x32_bf16 v[52:55], v[164:167], v[148:151], v[52:55]
    buffer_load_dwordx4 v183, s[24:27], s70 offen offset:3072 lds
    v_mfma_f32_16x16x32_bf16 v[60:63], v[164:167], v[152:155], v[60:63]
    s_add_u32 s70, s70, 128
    v_mfma_f32_16x16x32_bf16 v[40:43], v[168:171], v[140:143], v[40:43]
    v_mfma_f32_16x16x32_bf16 v[48:51], v[168:171], v[144:147], v[48:51]
    s_waitcnt lgkmcnt(0)
    s_waitcnt vmcnt(10)
    s_barrier
    ds_read_b128 v[100:103], v192 offset:0
    ds_read_b64_tr_b16 v[124:125], v196 offset:2048
    v_mfma_f32_16x16x32_bf16 v[56:59], v[168:171], v[148:151], v[56:59]
    ds_read_b64_tr_b16 v[126:127], v196 offset:2560
    ds_read_b128 v[104:107], v192 offset:2048
    v_mfma_f32_16x16x32_bf16 v[64:67], v[168:171], v[152:155], v[64:67]
    ds_read_b128 v[108:111], v192 offset:4096
    v_mfma_f32_16x16x32_bf16 v[68:71], v[140:143], v[172:175], v[68:71]
    ds_read_b128 v[112:115], v192 offset:6144
    v_mfma_f32_16x16x32_bf16 v[76:79], v[144:147], v[172:175], v[76:79]
    ds_read_b64_tr_b16 v[128:129], v197 offset:2048
    v_mfma_f32_16x16x32_bf16 v[84:87], v[148:151], v[172:175], v[84:87]
    ds_read_b64_tr_b16 v[130:131], v197 offset:2560
    v_mfma_f32_16x16x32_bf16 v[92:95], v[152:155], v[172:175], v[92:95]
    ds_read_b64_tr_b16 v[132:133], v196 offset:4096
    v_mfma_f32_16x16x32_bf16 v[72:75], v[140:143], v[176:179], v[72:75]
    ds_read_b64_tr_b16 v[134:135], v196 offset:4608
    v_mfma_f32_16x16x32_bf16 v[80:83], v[144:147], v[176:179], v[80:83]
    ds_read_b64_tr_b16 v[136:137], v197 offset:4096
    v_mfma_f32_16x16x32_bf16 v[88:91], v[148:151], v[176:179], v[88:91]
    ds_read_b64_tr_b16 v[138:139], v197 offset:4608
    v_mfma_f32_16x16x32_bf16 v[96:99], v[152:155], v[176:179], v[96:99]
    s_waitcnt lgkmcnt(4)
    v_mfma_f32_16x16x32_bf16 v[36:39], v[124:127], v[100:103], v[36:39]
    ds_read_b128 v[140:143], v193 offset:0
    s_and_b32 s77, s62, 1
    v_mfma_f32_16x16x32_bf16 v[44:47], v[124:127], v[104:107], v[44:47]
    ds_read_b64_tr_b16 v[164:165], v196 offset:14336
    s_lshl_b32 s78, s61, 1
    v_mfma_f32_16x16x32_bf16 v[52:55], v[124:127], v[108:111], v[52:55]
    ds_read_b64_tr_b16 v[166:167], v196 offset:14848
    s_add_u32 s77, s77, s78
    v_mfma_f32_16x16x32_bf16 v[60:63], v[124:127], v[112:115], v[60:63]
    ds_read_b128 v[144:147], v193 offset:2048
    s_lshr_b32 s70, s62, 1
    v_mfma_f32_16x16x32_bf16 v[40:43], v[128:131], v[100:103], v[40:43]
    ds_read_b128 v[148:151], v193 offset:4096
    s_lshl_b32 s71, s70, 13
    v_mfma_f32_16x16x32_bf16 v[48:51], v[128:131], v[104:107], v[48:51]
    ds_read_b128 v[152:155], v193 offset:6144
    v_mfma_f32_16x16x32_bf16 v[56:59], v[128:131], v[108:111], v[56:59]
    ds_read_b64_tr_b16 v[168:169], v197 offset:14336
    s_lshl_b32 s74, s77, 18
    v_mfma_f32_16x16x32_bf16 v[64:67], v[128:131], v[112:115], v[64:67]
    s_waitcnt lgkmcnt(7)
    ds_read_b64_tr_b16 v[170:171], v197 offset:14848
    s_add_u32 s74, s74, s71
    v_mfma_f32_16x16x32_bf16 v[68:71], v[100:103], v[132:135], v[68:71]
    ds_read_b64_tr_b16 v[172:173], v196 offset:16384
    s_add_u32 s74, s74, 0x700000
    v_mfma_f32_16x16x32_bf16 v[76:79], v[104:107], v[132:135], v[76:79]
    ds_read_b64_tr_b16 v[174:175], v196 offset:16896
    s_add_u32 s44, s20, s74
    v_mfma_f32_16x16x32_bf16 v[84:87], v[108:111], v[132:135], v[84:87]
    ds_read_b64_tr_b16 v[176:177], v197 offset:16384
    v_mfma_f32_16x16x32_bf16 v[92:95], v[112:115], v[132:135], v[92:95]
    ds_read_b64_tr_b16 v[178:179], v197 offset:16896
    s_addc_u32 s45, s21, 0
    v_mfma_f32_16x16x32_bf16 v[72:75], v[100:103], v[136:139], v[72:75]
    ds_read_b128 v[212:215], v202 offset:256
    s_and_b32 s45, s45, 0xffff
    v_mfma_f32_16x16x32_bf16 v[80:83], v[104:107], v[136:139], v[80:83]
    ds_read_b128 v[216:219], v202 offset:320
    s_sub_u32 s46, 0x40000, s71
    v_mfma_f32_16x16x32_bf16 v[88:91], v[108:111], v[136:139], v[88:91]
    ds_read_b128 v[204:207], v202 offset:0
    s_mov_b32 s47, 0x00020000
    v_mfma_f32_16x16x32_bf16 v[96:99], v[112:115], v[136:139], v[96:99]
    s_waitcnt lgkmcnt(7)
    v_mfma_f32_16x16x32_bf16 v[36:39], v[164:167], v[140:143], v[36:39]
    s_add_u32 s74, s74, 4096
    v_mfma_f32_16x16x32_bf16 v[44:47], v[164:167], v[144:147], v[44:47]
    s_waitcnt lgkmcnt(0)
    s_waitcnt vmcnt(0)
    s_barrier
    ds_read_b128 v[100:103], v190 offset:0
    s_add_u32 s48, s20, s74
    v_mfma_f32_16x16x32_bf16 v[52:55], v[164:167], v[148:151], v[52:55]
    ds_read_b64_tr_b16 v[124:125], v194 offset:2048
    s_addc_u32 s49, s21, 0
    v_mfma_f32_16x16x32_bf16 v[60:63], v[164:167], v[152:155], v[60:63]
    ds_read_b64_tr_b16 v[126:127], v194 offset:2560
    s_and_b32 s49, s49, 0xffff
    v_mfma_f32_16x16x32_bf16 v[40:43], v[168:171], v[140:143], v[40:43]
    ds_read_b128 v[104:107], v190 offset:2048
    s_sub_u32 s50, 0x3f000, s71
    v_mfma_f32_16x16x32_bf16 v[48:51], v[168:171], v[144:147], v[48:51]
    ds_read_b128 v[108:111], v190 offset:4096
    v_mfma_f32_16x16x32_bf16 v[56:59], v[168:171], v[148:151], v[56:59]
    ds_read_b128 v[112:115], v190 offset:6144
    s_mov_b32 s51, 0x00020000
    v_mfma_f32_16x16x32_bf16 v[64:67], v[168:171], v[152:155], v[64:67]
    ds_read_b64_tr_b16 v[128:129], v195 offset:2048
    s_add_u32 s74, s74, 4096
    v_mfma_f32_16x16x32_bf16 v[68:71], v[140:143], v[172:175], v[68:71]
    ds_read_b64_tr_b16 v[130:131], v195 offset:2560
    s_lshl_b32 s78, s60, 1
    v_mfma_f32_16x16x32_bf16 v[76:79], v[144:147], v[172:175], v[76:79]
    ds_read_b64_tr_b16 v[132:133], v194 offset:4096
    s_add_u32 s74, s70, s78
    v_mfma_f32_16x16x32_bf16 v[84:87], v[148:151], v[172:175], v[84:87]
    ds_read_b64_tr_b16 v[134:135], v194 offset:4608
    v_mfma_f32_16x16x32_bf16 v[92:95], v[152:155], v[172:175], v[92:95]
    ds_read_b64_tr_b16 v[136:137], v195 offset:4096
    s_lshl_b32 s78, s74, 17
    v_mfma_f32_16x16x32_bf16 v[72:75], v[140:143], v[176:179], v[72:75]
    ds_read_b64_tr_b16 v[138:139], v195 offset:4608
    s_lshl_b32 s74, s77, 11
    v_mfma_f32_16x16x32_bf16 v[80:83], v[144:147], v[176:179], v[80:83]
    ds_read_b128 v[208:211], v202 offset:64
    s_add_u32 s78, s78, s74
    v_mfma_f32_16x16x32_bf16 v[88:91], v[148:151], v[176:179], v[88:91]
    ds_read_b128 v[220:223], v198 offset:0
    s_add_u32 s78, s78, 0xf00000
    v_mfma_f32_16x16x32_bf16 v[96:99], v[152:155], v[176:179], v[96:99]
    s_waitcnt lgkmcnt(6)
    v_mfma_f32_16x16x32_bf16 v[36:39], v[124:127], v[100:103], v[36:39]
    ds_read_b128 v[140:143], v191 offset:0
    v_mfma_f32_16x16x32_bf16 v[44:47], v[124:127], v[104:107], v[44:47]
    ds_read_b64_tr_b16 v[164:165], v194 offset:14336
    v_mfma_f32_16x16x32_bf16 v[52:55], v[124:127], v[108:111], v[52:55]
    ds_read_b64_tr_b16 v[166:167], v194 offset:14848
    v_mfma_f32_16x16x32_bf16 v[60:63], v[124:127], v[112:115], v[60:63]
    ds_read_b128 v[144:147], v191 offset:2048
    v_mfma_f32_16x16x32_bf16 v[40:43], v[128:131], v[100:103], v[40:43]
    ds_read_b128 v[148:151], v191 offset:4096
    v_mfma_f32_16x16x32_bf16 v[48:51], v[128:131], v[104:107], v[48:51]
    ds_read_b128 v[152:155], v191 offset:6144
    v_mfma_f32_16x16x32_bf16 v[56:59], v[128:131], v[108:111], v[56:59]
    ds_read_b64_tr_b16 v[168:169], v195 offset:14336
    v_mfma_f32_16x16x32_bf16 v[64:67], v[128:131], v[112:115], v[64:67]
    s_waitcnt lgkmcnt(9)
    ds_read_b64_tr_b16 v[170:171], v195 offset:14848
    v_mfma_f32_16x16x32_bf16 v[68:71], v[100:103], v[132:135], v[68:71]
    ds_read_b64_tr_b16 v[172:173], v194 offset:16384
    v_mfma_f32_16x16x32_bf16 v[76:79], v[104:107], v[132:135], v[76:79]
    ds_read_b64_tr_b16 v[174:175], v194 offset:16896
    v_mfma_f32_16x16x32_bf16 v[84:87], v[108:111], v[132:135], v[84:87]
    ds_read_b64_tr_b16 v[176:177], v195 offset:16384
    v_mfma_f32_16x16x32_bf16 v[92:95], v[112:115], v[132:135], v[92:95]
    ds_read_b64_tr_b16 v[178:179], v195 offset:16896
    v_mfma_f32_16x16x32_bf16 v[72:75], v[100:103], v[136:139], v[72:75]
    ds_read_b128 v[236:239], v198 offset:512
    v_mfma_f32_16x16x32_bf16 v[80:83], v[104:107], v[136:139], v[80:83]
    ds_read_b128 v[224:227], v198 offset:64
    v_mfma_f32_16x16x32_bf16 v[88:91], v[108:111], v[136:139], v[88:91]
    ds_read_b128 v[240:243], v198 offset:576
    v_mfma_f32_16x16x32_bf16 v[96:99], v[112:115], v[136:139], v[96:99]
    s_waitcnt lgkmcnt(7)
    v_mfma_f32_16x16x32_bf16 v[36:39], v[164:167], v[140:143], v[36:39]
    ds_read2_b32 v[184:185], v199 offset0:0 offset1:16
    v_mfma_f32_16x16x32_bf16 v[44:47], v[164:167], v[144:147], v[44:47]
    ds_read2_b32 v[116:117], v199 offset0:128 offset1:144
    v_mfma_f32_16x16x32_bf16 v[52:55], v[164:167], v[148:151], v[52:55]
    ds_read2_b32 v[186:187], v199 offset0:32 offset1:48
    v_mfma_f32_16x16x32_bf16 v[60:63], v[164:167], v[152:155], v[60:63]
    ds_read2_b32 v[118:119], v199 offset0:160 offset1:176
    v_mfma_f32_16x16x32_bf16 v[40:43], v[168:171], v[140:143], v[40:43]
    ds_read2_b32 v[188:189], v203 offset0:128 offset1:144
    v_mfma_f32_16x16x32_bf16 v[48:51], v[168:171], v[144:147], v[48:51]
    ds_read_b128 v[228:231], v198 offset:128
    v_mfma_f32_16x16x32_bf16 v[56:59], v[168:171], v[148:151], v[56:59]
    ds_read_b128 v[244:247], v198 offset:640
    v_mfma_f32_16x16x32_bf16 v[64:67], v[168:171], v[152:155], v[64:67]
    s_waitcnt lgkmcnt(10)
    ds_read_b128 v[232:235], v198 offset:192
    v_mfma_f32_16x16x32_bf16 v[68:71], v[140:143], v[172:175], v[68:71]
    ds_read_b128 v[248:251], v198 offset:704
    v_mfma_f32_16x16x32_bf16 v[76:79], v[144:147], v[172:175], v[76:79]
    v_mfma_f32_16x16x32_bf16 v[84:87], v[148:151], v[172:175], v[84:87]
    v_mfma_f32_16x16x32_bf16 v[92:95], v[152:155], v[172:175], v[92:95]
    v_mfma_f32_16x16x32_bf16 v[72:75], v[140:143], v[176:179], v[72:75]
    v_mfma_f32_16x16x32_bf16 v[80:83], v[144:147], v[176:179], v[80:83]
    v_mfma_f32_16x16x32_bf16 v[88:91], v[148:151], v[176:179], v[88:91]
    v_mfma_f32_16x16x32_bf16 v[96:99], v[152:155], v[176:179], v[96:99]
    s_lshl_b32 s76, s62, 13
    s_add_u32 s76, s76, 131072
    v_add_u32 v198, s76, v2
    s_waitcnt lgkmcnt(0)
    v_mul_f32 v180, 0x3e8293ee, v116
    v_mul_f32 v181, 0x3e8293ee, v117
    v_mul_f32 v182, 0x3e8293ee, v118
    v_mul_f32 v183, 0x3e8293ee, v119
    v_pk_fma_f32 v[36:37], v[212:213], v[184:185], v[36:37] op_sel:[0,0,0] op_sel_hi:[1,0,1] neg_lo:[0,1,0] neg_hi:[0,1,0]
    v_pk_fma_f32 v[38:39], v[214:215], v[184:185], v[38:39] op_sel:[0,0,0] op_sel_hi:[1,0,1] neg_lo:[0,1,0] neg_hi:[0,1,0]
    v_pk_fma_f32 v[40:41], v[216:217], v[184:185], v[40:41] op_sel:[0,0,0] op_sel_hi:[1,0,1] neg_lo:[0,1,0] neg_hi:[0,1,0]
    v_pk_fma_f32 v[42:43], v[218:219], v[184:185], v[42:43] op_sel:[0,0,0] op_sel_hi:[1,0,1] neg_lo:[0,1,0] neg_hi:[0,1,0]
    v_pk_fma_f32 v[44:45], v[212:213], v[184:185], v[44:45] op_sel:[0,1,0] op_sel_hi:[1,1,1] neg_lo:[0,1,0] neg_hi:[0,1,0]
    v_pk_fma_f32 v[46:47], v[214:215], v[184:185], v[46:47] op_sel:[0,1,0] op_sel_hi:[1,1,1] neg_lo:[0,1,0] neg_hi:[0,1,0]
    v_pk_fma_f32 v[48:49], v[216:217], v[184:185], v[48:49] op_sel:[0,1,0] op_sel_hi:[1,1,1] neg_lo:[0,1,0] neg_hi:[0,1,0]
    v_pk_fma_f32 v[50:51], v[218:219], v[184:185], v[50:51] op_sel:[0,1,0] op_sel_hi:[1,1,1] neg_lo:[0,1,0] neg_hi:[0,1,0]
    v_pk_mul_f32 v[36:37], v[36:37], v[116:117] op_sel:[0,0] op_sel_hi:[1,0]
    v_pk_mul_f32 v[38:39], v[38:39], v[116:117] op_sel:[0,0] op_sel_hi:[1,0]
    v_pk_mul_f32 v[40:41], v[40:41], v[116:117] op_sel:[0,0] op_sel_hi:[1,0]
    v_pk_mul_f32 v[42:43], v[42:43], v[116:117] op_sel:[0,0] op_sel_hi:[1,0]
    v_pk_mul_f32 v[44:45], v[44:45], v[116:117] op_sel:[0,1] op_sel_hi:[1,1]
    v_pk_mul_f32 v[46:47], v[46:47], v[116:117] op_sel:[0,1] op_sel_hi:[1,1]
    v_pk_mul_f32 v[48:49], v[48:49], v[116:117] op_sel:[0,1] op_sel_hi:[1,1]
    v_pk_mul_f32 v[50:51], v[50:51], v[116:117] op_sel:[0,1] op_sel_hi:[1,1]
    v_cvt_pk_bf16_f32 v36, v36, v37
    v_cvt_pk_bf16_f32 v37, v38, v39
    v_cvt_pk_bf16_f32 v38, v40, v41
    v_cvt_pk_bf16_f32 v39, v42, v43
    v_cvt_pk_bf16_f32 v40, v44, v45
    v_cvt_pk_bf16_f32 v41, v46, v47
    v_cvt_pk_bf16_f32 v42, v48, v49
    v_cvt_pk_bf16_f32 v43, v50, v51
    v_permlane16_swap_b32 v36, v40
    v_permlane16_swap_b32 v37, v41
    v_permlane16_swap_b32 v38, v42
    v_permlane16_swap_b32 v39, v43
    ds_write_b128 v198, v[36:39] offset:0
    ds_write_b128 v198, v[40:43] offset:1024
    v_pk_fma_f32 v[52:53], v[212:213], v[186:187], v[52:53] op_sel:[0,0,0] op_sel_hi:[1,0,1] neg_lo:[0,1,0] neg_hi:[0,1,0]
    v_pk_fma_f32 v[54:55], v[214:215], v[186:187], v[54:55] op_sel:[0,0,0] op_sel_hi:[1,0,1] neg_lo:[0,1,0] neg_hi:[0,1,0]
    v_pk_fma_f32 v[56:57], v[216:217], v[186:187], v[56:57] op_sel:[0,0,0] op_sel_hi:[1,0,1] neg_lo:[0,1,0] neg_hi:[0,1,0]
    v_pk_fma_f32 v[58:59], v[218:219], v[186:187], v[58:59] op_sel:[0,0,0] op_sel_hi:[1,0,1] neg_lo:[0,1,0] neg_hi:[0,1,0]
    v_pk_fma_f32 v[60:61], v[212:213], v[186:187], v[60:61] op_sel:[0,1,0] op_sel_hi:[1,1,1] neg_lo:[0,1,0] neg_hi:[0,1,0]
    v_pk_fma_f32 v[62:63], v[214:215], v[186:187], v[62:63] op_sel:[0,1,0] op_sel_hi:[1,1,1] neg_lo:[0,1,0] neg_hi:[0,1,0]
    v_pk_fma_f32 v[64:65], v[216:217], v[186:187], v[64:65] op_sel:[0,1,0] op_sel_hi:[1,1,1] neg_lo:[0,1,0] neg_hi:[0,1,0]
    v_pk_fma_f32 v[66:67], v[218:219], v[186:187], v[66:67] op_sel:[0,1,0] op_sel_hi:[1,1,1] neg_lo:[0,1,0] neg_hi:[0,1,0]
    v_pk_mul_f32 v[52:53], v[52:53], v[118:119] op_sel:[0,0] op_sel_hi:[1,0]
    v_pk_mul_f32 v[54:55], v[54:55], v[118:119] op_sel:[0,0] op_sel_hi:[1,0]
    v_pk_mul_f32 v[56:57], v[56:57], v[118:119] op_sel:[0,0] op_sel_hi:[1,0]
    v_pk_mul_f32 v[58:59], v[58:59], v[118:119] op_sel:[0,0] op_sel_hi:[1,0]
    v_pk_mul_f32 v[60:61], v[60:61], v[118:119] op_sel:[0,1] op_sel_hi:[1,1]
    v_pk_mul_f32 v[62:63], v[62:63], v[118:119] op_sel:[0,1] op_sel_hi:[1,1]
    v_pk_mul_f32 v[64:65], v[64:65], v[118:119] op_sel:[0,1] op_sel_hi:[1,1]
    v_pk_mul_f32 v[66:67], v[66:67], v[118:119] op_sel:[0,1] op_sel_hi:[1,1]
    v_cvt_pk_bf16_f32 v52, v52, v53
    v_cvt_pk_bf16_f32 v53, v54, v55
    v_cvt_pk_bf16_f32 v54, v56, v57
    v_cvt_pk_bf16_f32 v55, v58, v59
    v_cvt_pk_bf16_f32 v56, v60, v61
    v_cvt_pk_bf16_f32 v57, v62, v63
    v_cvt_pk_bf16_f32 v58, v64, v65
    v_cvt_pk_bf16_f32 v59, v66, v67
    v_permlane16_swap_b32 v52, v56
    v_permlane16_swap_b32 v53, v57
    v_permlane16_swap_b32 v54, v58
    v_permlane16_swap_b32 v55, v59
    ds_write_b128 v198, v[52:55] offset:4096
    ds_write_b128 v198, v[56:59] offset:5120
    v_pk_fma_f32 v[68:69], v[220:221], v[188:189], v[68:69] op_sel:[0,0,0] op_sel_hi:[1,0,1] neg_lo:[0,1,0] neg_hi:[0,1,0]
    v_pk_fma_f32 v[70:71], v[222:223], v[188:189], v[70:71] op_sel:[0,0,0] op_sel_hi:[1,0,1] neg_lo:[0,1,0] neg_hi:[0,1,0]
    v_pk_fma_f32 v[72:73], v[220:221], v[188:189], v[72:73] op_sel:[0,1,0] op_sel_hi:[1,1,1] neg_lo:[0,1,0] neg_hi:[0,1,0]
    v_pk_fma_f32 v[74:75], v[222:223], v[188:189], v[74:75] op_sel:[0,1,0] op_sel_hi:[1,1,1] neg_lo:[0,1,0] neg_hi:[0,1,0]
    v_pk_fma_f32 v[76:77], v[224:225], v[188:189], v[76:77] op_sel:[0,0,0] op_sel_hi:[1,0,1] neg_lo:[0,1,0] neg_hi:[0,1,0]
    v_pk_fma_f32 v[78:79], v[226:227], v[188:189], v[78:79] op_sel:[0,0,0] op_sel_hi:[1,0,1] neg_lo:[0,1,0] neg_hi:[0,1,0]
    v_pk_fma_f32 v[80:81], v[224:225], v[188:189], v[80:81] op_sel:[0,1,0] op_sel_hi:[1,1,1] neg_lo:[0,1,0] neg_hi:[0,1,0]
    v_pk_fma_f32 v[82:83], v[226:227], v[188:189], v[82:83] op_sel:[0,1,0] op_sel_hi:[1,1,1] neg_lo:[0,1,0] neg_hi:[0,1,0]
    v_pk_mul_f32 v[68:69], v[68:69], v[236:237]
    v_pk_mul_f32 v[70:71], v[70:71], v[238:239]
    v_pk_mul_f32 v[72:73], v[72:73], v[236:237]
    v_pk_mul_f32 v[74:75], v[74:75], v[238:239]
    v_pk_mul_f32 v[76:77], v[76:77], v[240:241]
    v_pk_mul_f32 v[78:79], v[78:79], v[242:243]
    v_pk_mul_f32 v[80:81], v[80:81], v[240:241]
    v_pk_mul_f32 v[82:83], v[82:83], v[242:243]
    v_cvt_pk_bf16_f32 v68, v68, v69
    v_cvt_pk_bf16_f32 v69, v70, v71
    v_cvt_pk_bf16_f32 v70, v72, v73
    v_cvt_pk_bf16_f32 v71, v74, v75
    v_cvt_pk_bf16_f32 v72, v76, v77
    v_cvt_pk_bf16_f32 v73, v78, v79
    v_cvt_pk_bf16_f32 v74, v80, v81
    v_cvt_pk_bf16_f32 v75, v82, v83
    v_permlane16_swap_b32 v68, v70
    v_permlane16_swap_b32 v69, v71
    v_permlane16_swap_b32 v72, v74
    v_permlane16_swap_b32 v73, v75
    v_permlane32_swap_b32 v68, v70
    v_permlane32_swap_b32 v69, v71
    v_permlane32_swap_b32 v72, v74
    v_permlane32_swap_b32 v73, v75
    ds_write_b128 v198, v[68:71] offset:2048
    ds_write_b128 v198, v[72:75] offset:3072
    v_pk_fma_f32 v[84:85], v[228:229], v[188:189], v[84:85] op_sel:[0,0,0] op_sel_hi:[1,0,1] neg_lo:[0,1,0] neg_hi:[0,1,0]
    v_pk_fma_f32 v[86:87], v[230:231], v[188:189], v[86:87] op_sel:[0,0,0] op_sel_hi:[1,0,1] neg_lo:[0,1,0] neg_hi:[0,1,0]
    v_pk_fma_f32 v[88:89], v[228:229], v[188:189], v[88:89] op_sel:[0,1,0] op_sel_hi:[1,1,1] neg_lo:[0,1,0] neg_hi:[0,1,0]
    v_pk_fma_f32 v[90:91], v[230:231], v[188:189], v[90:91] op_sel:[0,1,0] op_sel_hi:[1,1,1] neg_lo:[0,1,0] neg_hi:[0,1,0]
    v_pk_fma_f32 v[92:93], v[232:233], v[188:189], v[92:93] op_sel:[0,0,0] op_sel_hi:[1,0,1] neg_lo:[0,1,0] neg_hi:[0,1,0]
    v_pk_fma_f32 v[94:95], v[234:235], v[188:189], v[94:95] op_sel:[0,0,0] op_sel_hi:[1,0,1] neg_lo:[0,1,0] neg_hi:[0,1,0]
    v_pk_fma_f32 v[96:97], v[232:233], v[188:189], v[96:97] op_sel:[0,1,0] op_sel_hi:[1,1,1] neg_lo:[0,1,0] neg_hi:[0,1,0]
    v_pk_fma_f32 v[98:99], v[234:235], v[188:189], v[98:99] op_sel:[0,1,0] op_sel_hi:[1,1,1] neg_lo:[0,1,0] neg_hi:[0,1,0]
    v_pk_mul_f32 v[84:85], v[84:85], v[244:245]
    v_pk_mul_f32 v[86:87], v[86:87], v[246:247]
    v_pk_mul_f32 v[88:89], v[88:89], v[244:245]
    v_pk_mul_f32 v[90:91], v[90:91], v[246:247]
    v_pk_mul_f32 v[92:93], v[92:93], v[248:249]
    v_pk_mul_f32 v[94:95], v[94:95], v[250:251]
    v_pk_mul_f32 v[96:97], v[96:97], v[248:249]
    v_pk_mul_f32 v[98:99], v[98:99], v[250:251]
    v_cvt_pk_bf16_f32 v84, v84, v85
    v_cvt_pk_bf16_f32 v85, v86, v87
    v_cvt_pk_bf16_f32 v86, v88, v89
    v_cvt_pk_bf16_f32 v87, v90, v91
    v_cvt_pk_bf16_f32 v88, v92, v93
    v_cvt_pk_bf16_f32 v89, v94, v95
    v_cvt_pk_bf16_f32 v90, v96, v97
    v_cvt_pk_bf16_f32 v91, v98, v99
    v_permlane16_swap_b32 v84, v86
    v_permlane16_swap_b32 v85, v87
    v_permlane16_swap_b32 v88, v90
    v_permlane16_swap_b32 v89, v91
    v_permlane32_swap_b32 v84, v86
    v_permlane32_swap_b32 v85, v87
    v_permlane32_swap_b32 v88, v90
    v_permlane32_swap_b32 v89, v91
    ds_write_b128 v198, v[84:87] offset:6144
    ds_write_b128 v198, v[88:91] offset:7168
    s_mul_i32 s76, s62, 6144
    s_add_u32 s76, s76, 59392
    ds_read_b128 v[140:143], v190 offset:40960
    ds_read_b64_tr_b16 v[156:157], v194 offset:40960
    ds_read_b64_tr_b16 v[158:159], v194 offset:41472
    ds_read_b128 v[144:147], v190 offset:43008
    ds_read_b128 v[148:151], v190 offset:45056
    ds_read_b128 v[152:155], v190 offset:47104
    ds_read_b64_tr_b16 v[160:161], v195 offset:40960
    ds_read_b64_tr_b16 v[162:163], v195 offset:41472
    s_waitcnt lgkmcnt(8)
    s_barrier
    ds_read_b128 v[220:223], v191 offset:40960
    ds_read_b64_tr_b16 v[236:237], v194 offset:53248
    ds_read_b64_tr_b16 v[238:239], v194 offset:53760
    ds_read_b128 v[224:227], v191 offset:43008
    ds_read_b128 v[228:231], v191 offset:45056
    ds_read_b128 v[232:235], v191 offset:47104
    ds_read_b64_tr_b16 v[240:241], v195 offset:53248
    ds_read_b64_tr_b16 v[242:243], v195 offset:53760
    v_add_u32 v198, s76, v2
    s_waitcnt lgkmcnt(8)
    v_mfma_f32_16x16x32_bf16 v[4:7], v[156:159], v[140:143], v[4:7]
    ds_read_b128 v[100:103], v192 offset:0
    v_mfma_f32_16x16x32_bf16 v[12:15], v[156:159], v[144:147], v[12:15]
    ds_read_b64_tr_b16 v[120:121], v196 offset:0
    v_mfma_f32_16x16x32_bf16 v[20:23], v[156:159], v[148:151], v[20:23]
    ds_read_b64_tr_b16 v[122:123], v196 offset:512
    v_mfma_f32_16x16x32_bf16 v[28:31], v[156:159], v[152:155], v[28:31]
    ds_read_b128 v[104:107], v192 offset:2048
    v_mfma_f32_16x16x32_bf16 v[8:11], v[160:163], v[140:143], v[8:11]
    ds_read_b128 v[108:111], v192 offset:4096
    v_mfma_f32_16x16x32_bf16 v[16:19], v[160:163], v[144:147], v[16:19]
    ds_read_b128 v[112:115], v192 offset:6144
    v_mfma_f32_16x16x32_bf16 v[24:27], v[160:163], v[148:151], v[24:27]
    ds_read_b64_tr_b16 v[124:125], v197 offset:0
    v_mfma_f32_16x16x32_bf16 v[32:35], v[160:163], v[152:155], v[32:35]
    ds_read_b64_tr_b16 v[126:127], v197 offset:512
    s_waitcnt lgkmcnt(8)
    v_mfma_f32_16x16x32_bf16 v[4:7], v[236:239], v[220:223], v[4:7]
    ds_read_b128 v[140:143], v193 offset:0
    v_mfma_f32_16x16x32_bf16 v[12:15], v[236:239], v[224:227], v[12:15]
    ds_read_b64_tr_b16 v[156:157], v196 offset:12288
    v_mfma_f32_16x16x32_bf16 v[20:23], v[236:239], v[228:231], v[20:23]
    ds_read_b64_tr_b16 v[158:159], v196 offset:12800
    v_mfma_f32_16x16x32_bf16 v[28:31], v[236:239], v[232:235], v[28:31]
    ds_read_b128 v[144:147], v193 offset:2048
    v_mfma_f32_16x16x32_bf16 v[8:11], v[240:243], v[220:223], v[8:11]
    ds_read_b128 v[148:151], v193 offset:4096
    v_mfma_f32_16x16x32_bf16 v[16:19], v[240:243], v[224:227], v[16:19]
    ds_read_b128 v[152:155], v193 offset:6144
    v_mfma_f32_16x16x32_bf16 v[24:27], v[240:243], v[228:231], v[24:27]
    ds_read_b64_tr_b16 v[160:161], v197 offset:12288
    v_mfma_f32_16x16x32_bf16 v[32:35], v[240:243], v[232:235], v[32:35]
    ds_read_b64_tr_b16 v[162:163], v197 offset:12800
    s_waitcnt lgkmcnt(8)
    v_mfma_f32_16x16x32_bf16 v[4:7], v[120:123], v[100:103], v[4:7]
    ds_read_b128 v[220:223], v190 offset:0
    v_mfma_f32_16x16x32_bf16 v[12:15], v[120:123], v[104:107], v[12:15]
    ds_read_b64_tr_b16 v[236:237], v194 offset:0
    v_mfma_f32_16x16x32_bf16 v[20:23], v[120:123], v[108:111], v[20:23]
    ds_read_b64_tr_b16 v[238:239], v194 offset:512
    v_mfma_f32_16x16x32_bf16 v[28:31], v[120:123], v[112:115], v[28:31]
    ds_read_b128 v[224:227], v190 offset:2048
    v_mfma_f32_16x16x32_bf16 v[8:11], v[124:127], v[100:103], v[8:11]
    ds_read_b128 v[228:231], v190 offset:4096
    v_mfma_f32_16x16x32_bf16 v[16:19], v[124:127], v[104:107], v[16:19]
    ds_read_b128 v[232:235], v190 offset:6144
    v_mfma_f32_16x16x32_bf16 v[24:27], v[124:127], v[108:111], v[24:27]
    ds_read_b64_tr_b16 v[240:241], v195 offset:0
    v_mfma_f32_16x16x32_bf16 v[32:35], v[124:127], v[112:115], v[32:35]
    ds_read_b64_tr_b16 v[242:243], v195 offset:512
    s_waitcnt lgkmcnt(8)
    v_mfma_f32_16x16x32_bf16 v[4:7], v[156:159], v[140:143], v[4:7]
    ds_read_b128 v[100:103], v191 offset:0
    v_mfma_f32_16x16x32_bf16 v[12:15], v[156:159], v[144:147], v[12:15]
    ds_read_b64_tr_b16 v[120:121], v194 offset:12288
    v_mfma_f32_16x16x32_bf16 v[20:23], v[156:159], v[148:151], v[20:23]
    ds_read_b64_tr_b16 v[122:123], v194 offset:12800
    v_mfma_f32_16x16x32_bf16 v[28:31], v[156:159], v[152:155], v[28:31]
    ds_read_b128 v[104:107], v191 offset:2048
    v_mfma_f32_16x16x32_bf16 v[8:11], v[160:163], v[140:143], v[8:11]
    ds_read_b128 v[108:111], v191 offset:4096
    v_mfma_f32_16x16x32_bf16 v[16:19], v[160:163], v[144:147], v[16:19]
    ds_read_b128 v[112:115], v191 offset:6144
    v_mfma_f32_16x16x32_bf16 v[24:27], v[160:163], v[148:151], v[24:27]
    ds_read_b64_tr_b16 v[124:125], v195 offset:12288
    v_mfma_f32_16x16x32_bf16 v[32:35], v[160:163], v[152:155], v[32:35]
    ds_read_b64_tr_b16 v[126:127], v195 offset:12800
    s_waitcnt lgkmcnt(8)
    v_mfma_f32_16x16x32_bf16 v[4:7], v[236:239], v[220:223], v[4:7]
    v_mfma_f32_16x16x32_bf16 v[12:15], v[236:239], v[224:227], v[12:15]
    v_mfma_f32_16x16x32_bf16 v[20:23], v[236:239], v[228:231], v[20:23]
    v_mfma_f32_16x16x32_bf16 v[28:31], v[236:239], v[232:235], v[28:31]
    v_mfma_f32_16x16x32_bf16 v[8:11], v[240:243], v[220:223], v[8:11]
    v_mfma_f32_16x16x32_bf16 v[16:19], v[240:243], v[224:227], v[16:19]
    v_mfma_f32_16x16x32_bf16 v[24:27], v[240:243], v[228:231], v[24:27]
    v_mfma_f32_16x16x32_bf16 v[32:35], v[240:243], v[232:235], v[32:35]
    s_waitcnt lgkmcnt(0)
    v_mfma_f32_16x16x32_bf16 v[4:7], v[120:123], v[100:103], v[4:7]
    v_mfma_f32_16x16x32_bf16 v[12:15], v[120:123], v[104:107], v[12:15]
    v_mfma_f32_16x16x32_bf16 v[20:23], v[120:123], v[108:111], v[20:23]
    v_mfma_f32_16x16x32_bf16 v[28:31], v[120:123], v[112:115], v[28:31]
    v_mfma_f32_16x16x32_bf16 v[8:11], v[124:127], v[100:103], v[8:11]
    v_mfma_f32_16x16x32_bf16 v[16:19], v[124:127], v[104:107], v[16:19]
    v_mfma_f32_16x16x32_bf16 v[24:27], v[124:127], v[108:111], v[24:27]
    v_mfma_f32_16x16x32_bf16 v[32:35], v[124:127], v[112:115], v[32:35]
    s_nop 7
    v_pk_fma_f32 v[4:5], v[204:205], v[184:185], v[4:5] op_sel:[0,0,0] op_sel_hi:[1,0,1] neg_lo:[0,1,0] neg_hi:[0,1,0]
    v_pk_fma_f32 v[6:7], v[206:207], v[184:185], v[6:7] op_sel:[0,0,0] op_sel_hi:[1,0,1] neg_lo:[0,1,0] neg_hi:[0,1,0]
    v_pk_fma_f32 v[8:9], v[208:209], v[184:185], v[8:9] op_sel:[0,0,0] op_sel_hi:[1,0,1] neg_lo:[0,1,0] neg_hi:[0,1,0]
    v_pk_fma_f32 v[10:11], v[210:211], v[184:185], v[10:11] op_sel:[0,0,0] op_sel_hi:[1,0,1] neg_lo:[0,1,0] neg_hi:[0,1,0]
    v_pk_fma_f32 v[12:13], v[204:205], v[184:185], v[12:13] op_sel:[0,1,0] op_sel_hi:[1,1,1] neg_lo:[0,1,0] neg_hi:[0,1,0]
    v_pk_fma_f32 v[14:15], v[206:207], v[184:185], v[14:15] op_sel:[0,1,0] op_sel_hi:[1,1,1] neg_lo:[0,1,0] neg_hi:[0,1,0]
    v_pk_fma_f32 v[16:17], v[208:209], v[184:185], v[16:17] op_sel:[0,1,0] op_sel_hi:[1,1,1] neg_lo:[0,1,0] neg_hi:[0,1,0]
    v_pk_fma_f32 v[18:19], v[210:211], v[184:185], v[18:19] op_sel:[0,1,0] op_sel_hi:[1,1,1] neg_lo:[0,1,0] neg_hi:[0,1,0]
    v_pk_mul_f32 v[4:5], v[4:5], v[180:181] op_sel:[0,0] op_sel_hi:[1,0]
    v_pk_mul_f32 v[6:7], v[6:7], v[180:181] op_sel:[0,0] op_sel_hi:[1,0]
    v_pk_mul_f32 v[8:9], v[8:9], v[180:181] op_sel:[0,0] op_sel_hi:[1,0]
    v_pk_mul_f32 v[10:11], v[10:11], v[180:181] op_sel:[0,0] op_sel_hi:[1,0]
    v_pk_mul_f32 v[12:13], v[12:13], v[180:181] op_sel:[0,1] op_sel_hi:[1,1]
    v_pk_mul_f32 v[14:15], v[14:15], v[180:181] op_sel:[0,1] op_sel_hi:[1,1]
    v_pk_mul_f32 v[16:17], v[16:17], v[180:181] op_sel:[0,1] op_sel_hi:[1,1]
    v_pk_mul_f32 v[18:19], v[18:19], v[180:181] op_sel:[0,1] op_sel_hi:[1,1]
    v_cvt_pk_bf16_f32 v4, v4, v5
    v_cvt_pk_bf16_f32 v5, v6, v7
    v_cvt_pk_bf16_f32 v6, v8, v9
    v_cvt_pk_bf16_f32 v7, v10, v11
    v_cvt_pk_bf16_f32 v8, v12, v13
    v_cvt_pk_bf16_f32 v9, v14, v15
    v_cvt_pk_bf16_f32 v10, v16, v17
    v_cvt_pk_bf16_f32 v11, v18, v19
    v_permlane16_swap_b32 v4, v8
    v_permlane16_swap_b32 v5, v9
    v_permlane16_swap_b32 v6, v10
    v_permlane16_swap_b32 v7, v11
    ds_write_b128 v198, v[4:7] offset:0
    ds_write_b128 v198, v[8:11] offset:1024
    v_pk_fma_f32 v[20:21], v[204:205], v[186:187], v[20:21] op_sel:[0,0,0] op_sel_hi:[1,0,1] neg_lo:[0,1,0] neg_hi:[0,1,0]
    v_pk_fma_f32 v[22:23], v[206:207], v[186:187], v[22:23] op_sel:[0,0,0] op_sel_hi:[1,0,1] neg_lo:[0,1,0] neg_hi:[0,1,0]
    v_pk_fma_f32 v[24:25], v[208:209], v[186:187], v[24:25] op_sel:[0,0,0] op_sel_hi:[1,0,1] neg_lo:[0,1,0] neg_hi:[0,1,0]
    v_pk_fma_f32 v[26:27], v[210:211], v[186:187], v[26:27] op_sel:[0,0,0] op_sel_hi:[1,0,1] neg_lo:[0,1,0] neg_hi:[0,1,0]
    v_pk_fma_f32 v[28:29], v[204:205], v[186:187], v[28:29] op_sel:[0,1,0] op_sel_hi:[1,1,1] neg_lo:[0,1,0] neg_hi:[0,1,0]
    v_pk_fma_f32 v[30:31], v[206:207], v[186:187], v[30:31] op_sel:[0,1,0] op_sel_hi:[1,1,1] neg_lo:[0,1,0] neg_hi:[0,1,0]
    v_pk_fma_f32 v[32:33], v[208:209], v[186:187], v[32:33] op_sel:[0,1,0] op_sel_hi:[1,1,1] neg_lo:[0,1,0] neg_hi:[0,1,0]
    v_pk_fma_f32 v[34:35], v[210:211], v[186:187], v[34:35] op_sel:[0,1,0] op_sel_hi:[1,1,1] neg_lo:[0,1,0] neg_hi:[0,1,0]
    v_pk_mul_f32 v[20:21], v[20:21], v[182:183] op_sel:[0,0] op_sel_hi:[1,0]
    v_pk_mul_f32 v[22:23], v[22:23], v[182:183] op_sel:[0,0] op_sel_hi:[1,0]
    v_pk_mul_f32 v[24:25], v[24:25], v[182:183] op_sel:[0,0] op_sel_hi:[1,0]
    v_pk_mul_f32 v[26:27], v[26:27], v[182:183] op_sel:[0,0] op_sel_hi:[1,0]
    v_pk_mul_f32 v[28:29], v[28:29], v[182:183] op_sel:[0,1] op_sel_hi:[1,1]
    v_pk_mul_f32 v[30:31], v[30:31], v[182:183] op_sel:[0,1] op_sel_hi:[1,1]
    v_pk_mul_f32 v[32:33], v[32:33], v[182:183] op_sel:[0,1] op_sel_hi:[1,1]
    v_pk_mul_f32 v[34:35], v[34:35], v[182:183] op_sel:[0,1] op_sel_hi:[1,1]
    v_cvt_pk_bf16_f32 v20, v20, v21
    v_cvt_pk_bf16_f32 v21, v22, v23
    v_cvt_pk_bf16_f32 v22, v24, v25
    v_cvt_pk_bf16_f32 v23, v26, v27
    v_cvt_pk_bf16_f32 v24, v28, v29
    v_cvt_pk_bf16_f32 v25, v30, v31
    v_cvt_pk_bf16_f32 v26, v32, v33
    v_cvt_pk_bf16_f32 v27, v34, v35
    v_permlane16_swap_b32 v20, v24
    v_permlane16_swap_b32 v21, v25
    v_permlane16_swap_b32 v22, v26
    v_permlane16_swap_b32 v23, v27
    ds_write_b128 v198, v[20:23] offset:2048
    ds_write_b128 v198, v[24:27] offset:3072
    v_mfma_f32_32x32x16_bf16 v[164:179], v[36:39], v[4:7], 0
    v_mfma_f32_32x32x16_bf16 v[164:179], v[40:43], v[8:11], v[164:179]
    v_lshrrev_b32 v228, 4, v1
    v_lshrrev_b32 v229, 2, v1
    v_xor_b32 v228, v228, v229
    v_and_b32 v228, 1, v228
    v_and_or_b32 v228, v1, 11, v228
    v_cmp_eq_u32 vcc, 0, v228
    v_mov_b32 v229, 0x3f803f80
    v_lshlrev_b32 v230, 2, v1
    v_cndmask_b32 v92, 0, v229, vcc
    v_cndmask_b32 v93, 0, v229, vcc
    v_cndmask_b32 v94, 0, v229, vcc
    v_cndmask_b32 v95, 0, v229, vcc
    v_add_u32 v230, 129024, v230
    s_mov_b32 s80, 16
    v_mov_b32 v249, 129280
    s_xor_b32 s79, s62, 2
    s_mul_i32 s79, s79, 6144
    s_add_u32 s79, s79, 59392
    v_add_u32 v232, s79, v2
    v_mfma_f32_32x32x16_bf16 v[180:195], v[36:39], v[20:23], 0
    v_exp_f32 v164, v164
    v_exp_f32 v165, v165
    v_exp_f32 v166, v166
    v_mfma_f32_32x32x16_bf16 v[180:195], v[40:43], v[24:27], v[180:195]
    v_exp_f32 v167, v167
    v_exp_f32 v168, v168
    v_exp_f32 v169, v169
    v_cvt_pk_bf16_f32 v76, v164, v165
    v_exp_f32 v170, v170
    v_exp_f32 v171, v171
    v_cvt_pk_bf16_f32 v77, v166, v167
    v_cvt_pk_bf16_f32 v78, v168, v169
    v_cvt_pk_bf16_f32 v79, v170, v171
    v_exp_f32 v172, v172
    v_exp_f32 v173, v173
    v_mfma_f32_32x32x16_bf16 v[100:115], v[68:71], v[76:79], 0
    v_exp_f32 v174, v174
    v_exp_f32 v175, v175
    v_exp_f32 v176, v176
    v_cvt_pk_bf16_f32 v80, v172, v173
    v_mfma_f32_16x16x32_bf16 v[44:47], v[92:95], v[76:79], 0
    v_exp_f32 v177, v177
    v_exp_f32 v178, v178
    v_exp_f32 v179, v179
    v_cvt_pk_bf16_f32 v81, v174, v175
    v_cvt_pk_bf16_f32 v82, v176, v177
    v_cvt_pk_bf16_f32 v83, v178, v179
    s_waitcnt lgkmcnt(0)
    s_barrier
    v_mfma_f32_32x32x16_bf16 v[164:179], v[52:55], v[4:7], 0
    ds_read_b128 v[12:15], v232 offset:0
    v_exp_f32 v180, v180
    v_exp_f32 v181, v181
    v_exp_f32 v182, v182
    v_mfma_f32_32x32x16_bf16 v[164:179], v[56:59], v[8:11], v[164:179]
    ds_read_b128 v[16:19], v232 offset:1024
    v_exp_f32 v183, v183
    v_exp_f32 v184, v184
    v_exp_f32 v185, v185
    v_cvt_pk_bf16_f32 v76, v180, v181
    v_mfma_f32_32x32x16_bf16 v[100:115], v[72:75], v[80:83], v[100:115]
    ds_read_b128 v[28:31], v232 offset:2048
    v_exp_f32 v186, v186
    v_exp_f32 v187, v187
    v_cvt_pk_bf16_f32 v77, v182, v183
    v_cvt_pk_bf16_f32 v78, v184, v185
    v_mfma_f32_16x16x32_bf16 v[44:47], v[92:95], v[80:83], v[44:47]
    ds_read_b128 v[32:35], v232 offset:3072
    v_cvt_pk_bf16_f32 v79, v186, v187
    v_exp_f32 v188, v188
    v_exp_f32 v189, v189
    v_mfma_f32_32x32x16_bf16 v[116:131], v[68:71], v[76:79], 0
    v_exp_f32 v190, v190
    v_exp_f32 v191, v191
    v_exp_f32 v192, v192
    v_cvt_pk_bf16_f32 v80, v188, v189
    v_mfma_f32_16x16x32_bf16 v[48:51], v[92:95], v[76:79], 0
    s_waitcnt lgkmcnt(0)
    v_exp_f32 v193, v193
    v_exp_f32 v194, v194
    v_exp_f32 v195, v195
    v_cvt_pk_bf16_f32 v81, v190, v191
    v_cvt_pk_bf16_f32 v82, v192, v193
    v_cvt_pk_bf16_f32 v83, v194, v195
    v_mfma_f32_32x32x16_bf16 v[180:195], v[36:39], v[12:15], 0
    v_exp_f32 v164, v164
    v_exp_f32 v165, v165
    v_exp_f32 v166, v166
    v_mfma_f32_32x32x16_bf16 v[180:195], v[40:43], v[16:19], v[180:195]
    v_exp_f32 v167, v167
    v_exp_f32 v168, v168
    v_exp_f32 v169, v169
    v_cvt_pk_bf16_f32 v76, v164, v165
    v_mfma_f32_32x32x16_bf16 v[116:131], v[72:75], v[80:83], v[116:131]
    v_exp_f32 v170, v170
    v_exp_f32 v171, v171
    v_cvt_pk_bf16_f32 v77, v166, v167
    v_cvt_pk_bf16_f32 v78, v168, v169
    v_mfma_f32_16x16x32_bf16 v[48:51], v[92:95], v[80:83], v[48:51]
    v_cvt_pk_bf16_f32 v79, v170, v171
    v_exp_f32 v172, v172
    v_exp_f32 v173, v173
    v_mfma_f32_32x32x16_bf16 v[100:115], v[84:87], v[76:79], v[100:115]
    v_exp_f32 v174, v174
    v_exp_f32 v175, v175
    v_exp_f32 v176, v176
    v_cvt_pk_bf16_f32 v80, v172, v173
    v_mfma_f32_16x16x32_bf16 v[44:47], v[92:95], v[76:79], v[44:47]
    v_exp_f32 v177, v177
    v_exp_f32 v178, v178
    v_exp_f32 v179, v179
    v_cvt_pk_bf16_f32 v81, v174, v175
    v_cvt_pk_bf16_f32 v82, v176, v177
    v_cvt_pk_bf16_f32 v83, v178, v179
    s_barrier
    ds_read_b32 v231, v230
    v_mfma_f32_32x32x16_bf16 v[164:179], v[36:39], v[28:31], 0
    v_exp_f32 v180, v180
    v_exp_f32 v181, v181
    v_exp_f32 v182, v182
    v_mfma_f32_32x32x16_bf16 v[164:179], v[40:43], v[32:35], v[164:179]
    s_waitcnt lgkmcnt(0)
    v_readlane_b32 s79, v231, 17
    v_exp_f32 v183, v183
    v_exp_f32 v184, v184
    v_exp_f32 v185, v185
    v_cvt_pk_bf16_f32 v76, v180, v181
    v_mfma_f32_32x32x16_bf16 v[100:115], v[88:91], v[80:83], v[100:115]
    s_nop 0
    buffer_load_dwordx4 v[196:199], v2, s[44:47], s79 offen offset:0 sc1
    v_exp_f32 v186, v186
    v_exp_f32 v187, v187
    v_cvt_pk_bf16_f32 v77, v182, v183
    v_cvt_pk_bf16_f32 v78, v184, v185
    v_mfma_f32_16x16x32_bf16 v[44:47], v[92:95], v[80:83], v[44:47]
    buffer_load_dwordx4 v[200:203], v2, s[44:47], s79 offen offset:1024 sc1
    v_cvt_pk_bf16_f32 v79, v186, v187
    v_exp_f32 v188, v188
    v_exp_f32 v189, v189
    v_mfma_f32_32x32x16_bf16 v[132:147], v[68:71], v[76:79], 0
    buffer_load_dwordx4 v[204:207], v2, s[44:47], s79 offen offset:2048 sc1
    v_exp_f32 v190, v190
    v_exp_f32 v191, v191
    v_exp_f32 v192, v192
    v_cvt_pk_bf16_f32 v80, v188, v189
    v_mfma_f32_16x16x32_bf16 v[60:63], v[92:95], v[76:79], 0
    buffer_load_dwordx4 v[208:211], v2, s[44:47], s79 offen offset:3072 sc1
    v_exp_f32 v193, v193
    v_exp_f32 v194, v194
    v_exp_f32 v195, v195
    v_cvt_pk_bf16_f32 v81, v190, v191
    v_cvt_pk_bf16_f32 v82, v192, v193
    v_cvt_pk_bf16_f32 v83, v194, v195
    v_mfma_f32_32x32x16_bf16 v[180:195], v[52:55], v[12:15], 0
    buffer_load_dwordx4 v[212:215], v2, s[48:51], s79 offen offset:0 sc1
    v_exp_f32 v164, v164
    v_exp_f32 v165, v165
    v_exp_f32 v166, v166
    v_mfma_f32_32x32x16_bf16 v[180:195], v[56:59], v[16:19], v[180:195]
    buffer_load_dwordx4 v[216:219], v2, s[48:51], s79 offen offset:1024 sc1
    v_exp_f32 v167, v167
    v_exp_f32 v168, v168
    v_exp_f32 v169, v169
    v_cvt_pk_bf16_f32 v76, v164, v165
    v_mfma_f32_32x32x16_bf16 v[132:147], v[72:75], v[80:83], v[132:147]
    buffer_load_dwordx4 v[220:223], v2, s[48:51], s79 offen offset:2048 sc1
    v_exp_f32 v170, v170
    v_exp_f32 v171, v171
    v_cvt_pk_bf16_f32 v77, v166, v167
    v_cvt_pk_bf16_f32 v78, v168, v169
    v_mfma_f32_16x16x32_bf16 v[60:63], v[92:95], v[80:83], v[60:63]
    buffer_load_dwordx4 v[224:227], v2, s[48:51], s79 offen offset:3072 sc1
    v_cvt_pk_bf16_f32 v79, v170, v171
    v_exp_f32 v172, v172
    v_exp_f32 v173, v173
    v_mfma_f32_32x32x16_bf16 v[148:163], v[68:71], v[76:79], 0
    v_exp_f32 v174, v174
    v_exp_f32 v175, v175
    v_exp_f32 v176, v176
    v_cvt_pk_bf16_f32 v80, v172, v173
    v_mfma_f32_16x16x32_bf16 v[64:67], v[92:95], v[76:79], 0
    v_exp_f32 v177, v177
    v_exp_f32 v178, v178
    v_exp_f32 v179, v179
    v_cvt_pk_bf16_f32 v81, v174, v175
    v_cvt_pk_bf16_f32 v82, v176, v177
    v_cvt_pk_bf16_f32 v83, v178, v179
    v_mfma_f32_32x32x16_bf16 v[164:179], v[52:55], v[28:31], 0
    ds_read_b32 v231, v230
    v_exp_f32 v180, v180
    v_exp_f32 v181, v181
    v_exp_f32 v182, v182
    v_mfma_f32_32x32x16_bf16 v[164:179], v[56:59], v[32:35], v[164:179]
    s_waitcnt lgkmcnt(0)
    v_exp_f32 v183, v183
    v_exp_f32 v184, v184
    v_exp_f32 v185, v185
    v_cvt_pk_bf16_f32 v76, v180, v181
    v_mfma_f32_32x32x16_bf16 v[148:163], v[72:75], v[80:83], v[148:163]
    v_exp_f32 v186, v186
    v_exp_f32 v187, v187
    v_cvt_pk_bf16_f32 v77, v182, v183
    v_cvt_pk_bf16_f32 v78, v184, v185
    v_mfma_f32_16x16x32_bf16 v[64:67], v[92:95], v[80:83], v[64:67]
    v_readlane_b32 s79, v231, s80
    v_cvt_pk_bf16_f32 v79, v186, v187
    v_exp_f32 v188, v188
    v_exp_f32 v189, v189
    v_mfma_f32_32x32x16_bf16 v[132:147], v[84:87], v[76:79], v[132:147]
    s_cmp_eq_u32 s79, -1
    v_exp_f32 v190, v190
    v_exp_f32 v191, v191
    v_exp_f32 v192, v192
    v_cvt_pk_bf16_f32 v80, v188, v189
    v_mfma_f32_16x16x32_bf16 v[60:63], v[92:95], v[76:79], v[60:63]
    s_cbranch_scc1 L_lwp
L_lop:
    v_exp_f32 v193, v193
    v_exp_f32 v194, v194
    v_exp_f32 v195, v195
    v_cvt_pk_bf16_f32 v81, v190, v191
    v_cvt_pk_bf16_f32 v82, v192, v193
    v_cvt_pk_bf16_f32 v83, v194, v195
    v_mfma_f32_32x32x16_bf16 v[180:195], v[52:55], v[20:23], 0
    v_exp_f32 v164, v164
    v_exp_f32 v165, v165
    v_exp_f32 v166, v166
    v_mfma_f32_32x32x16_bf16 v[180:195], v[56:59], v[24:27], v[180:195]
    v_exp_f32 v167, v167
    v_exp_f32 v168, v168
    v_exp_f32 v169, v169
    v_cvt_pk_bf16_f32 v76, v164, v165
    v_mfma_f32_32x32x16_bf16 v[132:147], v[88:91], v[80:83], v[132:147]
    buffer_load_dwordx4 v[36:39], v2, s[44:47], s79 offen offset:0 sc1
    v_exp_f32 v170, v170
    v_exp_f32 v171, v171
    v_cvt_pk_bf16_f32 v77, v166, v167
    v_cvt_pk_bf16_f32 v78, v168, v169
    v_mfma_f32_16x16x32_bf16 v[60:63], v[92:95], v[80:83], v[60:63]
    buffer_load_dwordx4 v[40:43], v2, s[44:47], s79 offen offset:1024 sc1
    v_cvt_pk_bf16_f32 v79, v170, v171
    v_exp_f32 v172, v172
    v_exp_f32 v173, v173
    v_mfma_f32_32x32x16_bf16 v[148:163], v[84:87], v[76:79], v[148:163]
    buffer_load_dwordx4 v[68:71], v2, s[44:47], s79 offen offset:2048 sc1
    v_exp_f32 v174, v174
    v_exp_f32 v175, v175
    v_exp_f32 v176, v176
    v_cvt_pk_bf16_f32 v80, v172, v173
    v_mfma_f32_16x16x32_bf16 v[64:67], v[92:95], v[76:79], v[64:67]
    s_waitcnt vmcnt(7)
    v_exp_f32 v177, v177
    v_exp_f32 v178, v178
    v_exp_f32 v179, v179
    v_cvt_pk_bf16_f32 v81, v174, v175
    v_cvt_pk_bf16_f32 v82, v176, v177
    v_cvt_pk_bf16_f32 v83, v178, v179
    v_mfma_f32_32x32x16_bf16 v[164:179], v[196:199], v[12:15], 0
    v_exp_f32 v180, v180
    v_exp_f32 v181, v181
    v_exp_f32 v182, v182
    v_mfma_f32_32x32x16_bf16 v[164:179], v[200:203], v[16:19], v[164:179]
    v_exp_f32 v183, v183
    v_exp_f32 v184, v184
    v_exp_f32 v185, v185
    v_cvt_pk_bf16_f32 v76, v180, v181
    v_mfma_f32_32x32x16_bf16 v[148:163], v[88:91], v[80:83], v[148:163]
    buffer_load_dwordx4 v[72:75], v2, s[44:47], s79 offen offset:3072 sc1
    v_exp_f32 v186, v186
    v_exp_f32 v187, v187
    v_cvt_pk_bf16_f32 v77, v182, v183
    v_cvt_pk_bf16_f32 v78, v184, v185
    v_mfma_f32_16x16x32_bf16 v[64:67], v[92:95], v[80:83], v[64:67]
    s_mov_b32 s80, 15
    v_cvt_pk_bf16_f32 v79, v186, v187
    v_exp_f32 v188, v188
    v_exp_f32 v189, v189
    v_mfma_f32_32x32x16_bf16 v[116:131], v[84:87], v[76:79], v[116:131]
    v_exp_f32 v190, v190
    v_exp_f32 v191, v191
    v_exp_f32 v192, v192
    v_cvt_pk_bf16_f32 v80, v188, v189
    v_mfma_f32_16x16x32_bf16 v[48:51], v[92:95], v[76:79], v[48:51]
    v_exp_f32 v193, v193
    v_exp_f32 v194, v194
    v_exp_f32 v195, v195
    v_cvt_pk_bf16_f32 v81, v190, v191
    v_cvt_pk_bf16_f32 v82, v192, v193
    v_cvt_pk_bf16_f32 v83, v194, v195
    v_mfma_f32_32x32x16_bf16 v[180:195], v[196:199], v[28:31], 0
.p2align 6
L_attn:
    v_exp_f32 v164, v164
    v_exp_f32 v165, v165
    v_exp_f32 v166, v166
    v_mfma_f32_32x32x16_bf16 v[180:195], v[200:203], v[32:35], v[180:195]
    v_exp_f32 v167, v167
    v_exp_f32 v168, v168
    v_exp_f32 v169, v169
    v_cvt_pk_bf16_f32 v76, v164, v165
    v_mfma_f32_32x32x16_bf16 v[116:131], v[88:91], v[80:83], v[116:131]
    buffer_load_dwordx4 v[52:55], v2, s[48:51], s79 offen offset:0 sc1
    v_exp_f32 v170, v170
    v_exp_f32 v171, v171
    v_cvt_pk_bf16_f32 v77, v166, v167
    v_cvt_pk_bf16_f32 v78, v168, v169
    v_mfma_f32_16x16x32_bf16 v[48:51], v[92:95], v[80:83], v[48:51]
    v_cvt_pk_bf16_f32 v79, v170, v171
    v_exp_f32 v172, v172
    v_exp_f32 v173, v173
    v_mfma_f32_32x32x16_bf16 v[132:147], v[204:207], v[76:79], v[132:147]
    v_exp_f32 v174, v174
    v_exp_f32 v175, v175
    v_exp_f32 v176, v176
    v_cvt_pk_bf16_f32 v80, v172, v173
    v_mfma_f32_16x16x32_bf16 v[60:63], v[92:95], v[76:79], v[60:63]
    v_exp_f32 v177, v177
    v_exp_f32 v178, v178
    v_exp_f32 v179, v179
    v_cvt_pk_bf16_f32 v81, v174, v175
    v_cvt_pk_bf16_f32 v82, v176, v177
    v_cvt_pk_bf16_f32 v83, v178, v179
    v_mfma_f32_32x32x16_bf16 v[164:179], v[196:199], v[4:7], 0
    v_exp_f32 v180, v180
    v_exp_f32 v181, v181
    v_exp_f32 v182, v182
    v_mfma_f32_32x32x16_bf16 v[164:179], v[200:203], v[8:11], v[164:179]
    v_exp_f32 v183, v183
    v_exp_f32 v184, v184
    v_exp_f32 v185, v185
    v_cvt_pk_bf16_f32 v76, v180, v181
    v_mfma_f32_32x32x16_bf16 v[132:147], v[208:211], v[80:83], v[132:147]
    buffer_load_dwordx4 v[56:59], v2, s[48:51], s79 offen offset:1024 sc1
    v_exp_f32 v186, v186
    v_exp_f32 v187, v187
    v_cvt_pk_bf16_f32 v77, v182, v183
    v_cvt_pk_bf16_f32 v78, v184, v185
    v_mfma_f32_16x16x32_bf16 v[60:63], v[92:95], v[80:83], v[60:63]
    v_cvt_pk_bf16_f32 v79, v186, v187
    v_exp_f32 v188, v188
    v_exp_f32 v189, v189
    v_mfma_f32_32x32x16_bf16 v[148:163], v[204:207], v[76:79], v[148:163]
    v_exp_f32 v190, v190
    v_exp_f32 v191, v191
    v_exp_f32 v192, v192
    v_cvt_pk_bf16_f32 v80, v188, v189
    v_mfma_f32_16x16x32_bf16 v[64:67], v[92:95], v[76:79], v[64:67]
    v_exp_f32 v193, v193
    v_exp_f32 v194, v194
    v_exp_f32 v195, v195
    v_cvt_pk_bf16_f32 v81, v190, v191
    v_cvt_pk_bf16_f32 v82, v192, v193
    v_cvt_pk_bf16_f32 v83, v194, v195
    v_mfma_f32_32x32x16_bf16 v[180:195], v[196:199], v[20:23], 0
    ds_read_b32 v231, v230
    v_exp_f32 v164, v164
    v_exp_f32 v165, v165
    v_exp_f32 v166, v166
    v_mfma_f32_32x32x16_bf16 v[180:195], v[200:203], v[24:27], v[180:195]
    v_exp_f32 v167, v167
    v_exp_f32 v168, v168
    v_exp_f32 v169, v169
    v_cvt_pk_bf16_f32 v76, v164, v165
    v_mfma_f32_32x32x16_bf16 v[148:163], v[208:211], v[80:83], v[148:163]
    buffer_load_dwordx4 v[84:87], v2, s[48:51], s79 offen offset:2048 sc1
    v_exp_f32 v170, v170
    v_exp_f32 v171, v171
    v_cvt_pk_bf16_f32 v77, v166, v167
    v_cvt_pk_bf16_f32 v78, v168, v169
    v_mfma_f32_16x16x32_bf16 v[64:67], v[92:95], v[80:83], v[64:67]
    v_cvt_pk_bf16_f32 v79, v170, v171
    v_exp_f32 v172, v172
    v_exp_f32 v173, v173
    v_mfma_f32_32x32x16_bf16 v[100:115], v[204:207], v[76:79], v[100:115]
    v_exp_f32 v174, v174
    v_exp_f32 v175, v175
    v_exp_f32 v176, v176
    v_cvt_pk_bf16_f32 v80, v172, v173
    v_mfma_f32_16x16x32_bf16 v[44:47], v[92:95], v[76:79], v[44:47]
    s_waitcnt vmcnt(7)
    v_exp_f32 v177, v177
    v_exp_f32 v178, v178
    v_exp_f32 v179, v179
    v_cvt_pk_bf16_f32 v81, v174, v175
    v_cvt_pk_bf16_f32 v82, v176, v177
    v_cvt_pk_bf16_f32 v83, v178, v179
    v_mfma_f32_32x32x16_bf16 v[164:179], v[212:215], v[12:15], 0
    s_waitcnt lgkmcnt(0)
    v_exp_f32 v180, v180
    v_exp_f32 v181, v181
    v_exp_f32 v182, v182
    v_mfma_f32_32x32x16_bf16 v[164:179], v[216:219], v[16:19], v[164:179]
    v_exp_f32 v183, v183
    v_exp_f32 v184, v184
    v_exp_f32 v185, v185
    v_cvt_pk_bf16_f32 v76, v180, v181
    v_mfma_f32_32x32x16_bf16 v[100:115], v[208:211], v[80:83], v[100:115]
    buffer_load_dwordx4 v[88:91], v2, s[48:51], s79 offen offset:3072 sc1
    v_exp_f32 v186, v186
    v_exp_f32 v187, v187
    v_cvt_pk_bf16_f32 v77, v182, v183
    v_cvt_pk_bf16_f32 v78, v184, v185
    v_mfma_f32_16x16x32_bf16 v[44:47], v[92:95], v[80:83], v[44:47]
    v_readlane_b32 s79, v231, s80
    v_cvt_pk_bf16_f32 v79, v186, v187
    v_exp_f32 v188, v188
    v_exp_f32 v189, v189
    v_mfma_f32_32x32x16_bf16 v[116:131], v[204:207], v[76:79], v[116:131]
    s_cmp_eq_u32 s79, -1
    v_exp_f32 v190, v190
    v_exp_f32 v191, v191
    v_exp_f32 v192, v192
    v_cvt_pk_bf16_f32 v80, v188, v189
    v_mfma_f32_16x16x32_bf16 v[48:51], v[92:95], v[76:79], v[48:51]
    s_cbranch_scc1 L_lwh0
L_loh0:
    v_exp_f32 v193, v193
    v_exp_f32 v194, v194
    v_exp_f32 v195, v195
    v_cvt_pk_bf16_f32 v81, v190, v191
    v_cvt_pk_bf16_f32 v82, v192, v193
    v_cvt_pk_bf16_f32 v83, v194, v195
    v_mfma_f32_32x32x16_bf16 v[180:195], v[212:215], v[28:31], 0
    v_exp_f32 v164, v164
    v_exp_f32 v165, v165
    v_exp_f32 v166, v166
    v_mfma_f32_32x32x16_bf16 v[180:195], v[216:219], v[32:35], v[180:195]
    v_exp_f32 v167, v167
    v_exp_f32 v168, v168
    v_exp_f32 v169, v169
    v_cvt_pk_bf16_f32 v76, v164, v165
    v_mfma_f32_32x32x16_bf16 v[116:131], v[208:211], v[80:83], v[116:131]
    buffer_load_dwordx4 v[196:199], v2, s[44:47], s79 offen offset:0 sc1
    v_exp_f32 v170, v170
    v_exp_f32 v171, v171
    v_cvt_pk_bf16_f32 v77, v166, v167
    v_cvt_pk_bf16_f32 v78, v168, v169
    v_mfma_f32_16x16x32_bf16 v[48:51], v[92:95], v[80:83], v[48:51]
    v_cvt_pk_bf16_f32 v79, v170, v171
    v_exp_f32 v172, v172
    v_exp_f32 v173, v173
    v_mfma_f32_32x32x16_bf16 v[132:147], v[220:223], v[76:79], v[132:147]
    v_exp_f32 v174, v174
    v_exp_f32 v175, v175
    v_exp_f32 v176, v176
    v_cvt_pk_bf16_f32 v80, v172, v173
    v_mfma_f32_16x16x32_bf16 v[60:63], v[92:95], v[76:79], v[60:63]
    v_exp_f32 v177, v177
    v_exp_f32 v178, v178
    v_exp_f32 v179, v179
    v_cvt_pk_bf16_f32 v81, v174, v175
    v_cvt_pk_bf16_f32 v82, v176, v177
    v_cvt_pk_bf16_f32 v83, v178, v179
    v_mfma_f32_32x32x16_bf16 v[164:179], v[212:215], v[4:7], 0
    v_exp_f32 v180, v180
    v_exp_f32 v181, v181
    v_exp_f32 v182, v182
    v_mfma_f32_32x32x16_bf16 v[164:179], v[216:219], v[8:11], v[164:179]
    v_exp_f32 v183, v183
    v_exp_f32 v184, v184
    v_exp_f32 v185, v185
    v_cvt_pk_bf16_f32 v76, v180, v181
    v_mfma_f32_32x32x16_bf16 v[132:147], v[224:227], v[80:83], v[132:147]
    buffer_load_dwordx4 v[200:203], v2, s[44:47], s79 offen offset:1024 sc1
    v_exp_f32 v186, v186
    v_exp_f32 v187, v187
    v_cvt_pk_bf16_f32 v77, v182, v183
    v_cvt_pk_bf16_f32 v78, v184, v185
    v_mfma_f32_16x16x32_bf16 v[60:63], v[92:95], v[80:83], v[60:63]
    v_cvt_pk_bf16_f32 v79, v186, v187
    v_exp_f32 v188, v188
    v_exp_f32 v189, v189
    v_mfma_f32_32x32x16_bf16 v[148:163], v[220:223], v[76:79], v[148:163]
    v_exp_f32 v190, v190
    v_exp_f32 v191, v191
    v_exp_f32 v192, v192
    v_cvt_pk_bf16_f32 v80, v188, v189
    v_mfma_f32_16x16x32_bf16 v[64:67], v[92:95], v[76:79], v[64:67]
    v_exp_f32 v193, v193
    v_exp_f32 v194, v194
    v_exp_f32 v195, v195
    v_cvt_pk_bf16_f32 v81, v190, v191
    v_cvt_pk_bf16_f32 v82, v192, v193
    v_cvt_pk_bf16_f32 v83, v194, v195
    v_mfma_f32_32x32x16_bf16 v[180:195], v[212:215], v[20:23], 0
    v_exp_f32 v164, v164
    v_exp_f32 v165, v165
    v_exp_f32 v166, v166
    v_mfma_f32_32x32x16_bf16 v[180:195], v[216:219], v[24:27], v[180:195]
    v_exp_f32 v167, v167
    v_exp_f32 v168, v168
    v_exp_f32 v169, v169
    v_cvt_pk_bf16_f32 v76, v164, v165
    v_mfma_f32_32x32x16_bf16 v[148:163], v[224:227], v[80:83], v[148:163]
    buffer_load_dwordx4 v[204:207], v2, s[44:47], s79 offen offset:2048 sc1
    v_exp_f32 v170, v170
    v_exp_f32 v171, v171
    v_cvt_pk_bf16_f32 v77, v166, v167
    v_cvt_pk_bf16_f32 v78, v168, v169
    v_mfma_f32_16x16x32_bf16 v[64:67], v[92:95], v[80:83], v[64:67]
    v_cvt_pk_bf16_f32 v79, v170, v171
    v_exp_f32 v172, v172
    v_exp_f32 v173, v173
    v_mfma_f32_32x32x16_bf16 v[100:115], v[220:223], v[76:79], v[100:115]
    v_exp_f32 v174, v174
    v_exp_f32 v175, v175
    v_exp_f32 v176, v176
    v_cvt_pk_bf16_f32 v80, v172, v173
    v_mfma_f32_16x16x32_bf16 v[44:47], v[92:95], v[76:79], v[44:47]
    s_waitcnt vmcnt(7)
    v_exp_f32 v177, v177
    v_exp_f32 v178, v178
    v_exp_f32 v179, v179
    v_cvt_pk_bf16_f32 v81, v174, v175
    v_cvt_pk_bf16_f32 v82, v176, v177
    v_cvt_pk_bf16_f32 v83, v178, v179
    v_mfma_f32_32x32x16_bf16 v[164:179], v[36:39], v[12:15], 0
    s_cmp_eq_u32 s80, 1
    v_exp_f32 v180, v180
    v_exp_f32 v181, v181
    v_exp_f32 v182, v182
    v_mfma_f32_32x32x16_bf16 v[164:179], v[40:43], v[16:19], v[164:179]
    s_cbranch_scc1 L_hand
L_handed:
    v_exp_f32 v183, v183
    v_exp_f32 v184, v184
    v_exp_f32 v185, v185
    v_cvt_pk_bf16_f32 v76, v180, v181
    v_mfma_f32_32x32x16_bf16 v[100:115], v[224:227], v[80:83], v[100:115]
    buffer_load_dwordx4 v[208:211], v2, s[44:47], s79 offen offset:3072 sc1
    v_exp_f32 v186, v186
    v_exp_f32 v187, v187
    v_cvt_pk_bf16_f32 v77, v182, v183
    v_cvt_pk_bf16_f32 v78, v184, v185
    v_mfma_f32_16x16x32_bf16 v[44:47], v[92:95], v[80:83], v[44:47]
    s_sub_u32 s80, s80, 1
    v_cvt_pk_bf16_f32 v79, v186, v187
    v_exp_f32 v188, v188
    v_exp_f32 v189, v189
    v_mfma_f32_32x32x16_bf16 v[116:131], v[220:223], v[76:79], v[116:131]
    s_cmp_eq_u32 s80, 0
    v_exp_f32 v190, v190
    v_exp_f32 v191, v191
    v_exp_f32 v192, v192
    v_cvt_pk_bf16_f32 v80, v188, v189
    v_mfma_f32_16x16x32_bf16 v[48:51], v[92:95], v[76:79], v[48:51]
    v_exp_f32 v193, v193
    v_exp_f32 v194, v194
    v_exp_f32 v195, v195
    v_cvt_pk_bf16_f32 v81, v190, v191
    v_cvt_pk_bf16_f32 v82, v192, v193
    v_cvt_pk_bf16_f32 v83, v194, v195
    v_mfma_f32_32x32x16_bf16 v[180:195], v[36:39], v[28:31], 0
    s_cbranch_scc1 L_attn_done
    v_exp_f32 v164, v164
    v_exp_f32 v165, v165
    v_exp_f32 v166, v166
    v_mfma_f32_32x32x16_bf16 v[180:195], v[40:43], v[32:35], v[180:195]
    v_exp_f32 v167, v167
    v_exp_f32 v168, v168
    v_exp_f32 v169, v169
    v_cvt_pk_bf16_f32 v76, v164, v165
    v_mfma_f32_32x32x16_bf16 v[116:131], v[224:227], v[80:83], v[116:131]
    buffer_load_dwordx4 v[212:215], v2, s[48:51], s79 offen offset:0 sc1
    v_exp_f32 v170, v170
    v_exp_f32 v171, v171
    v_cvt_pk_bf16_f32 v77, v166, v167
    v_cvt_pk_bf16_f32 v78, v168, v169
    v_mfma_f32_16x16x32_bf16 v[48:51], v[92:95], v[80:83], v[48:51]
    v_cvt_pk_bf16_f32 v79, v170, v171
    v_exp_f32 v172, v172
    v_exp_f32 v173, v173
    v_mfma_f32_32x32x16_bf16 v[132:147], v[68:71], v[76:79], v[132:147]
    v_exp_f32 v174, v174
    v_exp_f32 v175, v175
    v_exp_f32 v176, v176
    v_cvt_pk_bf16_f32 v80, v172, v173
    v_mfma_f32_16x16x32_bf16 v[60:63], v[92:95], v[76:79], v[60:63]
    v_exp_f32 v177, v177
    v_exp_f32 v178, v178
    v_exp_f32 v179, v179
    v_cvt_pk_bf16_f32 v81, v174, v175
    v_cvt_pk_bf16_f32 v82, v176, v177
    v_cvt_pk_bf16_f32 v83, v178, v179
    v_mfma_f32_32x32x16_bf16 v[164:179], v[36:39], v[4:7], 0
    v_exp_f32 v180, v180
    v_exp_f32 v181, v181
    v_exp_f32 v182, v182
    v_mfma_f32_32x32x16_bf16 v[164:179], v[40:43], v[8:11], v[164:179]
    v_exp_f32 v183, v183
    v_exp_f32 v184, v184
    v_exp_f32 v185, v185
    v_cvt_pk_bf16_f32 v76, v180, v181
    v_mfma_f32_32x32x16_bf16 v[132:147], v[72:75], v[80:83], v[132:147]
    buffer_load_dwordx4 v[216:219], v2, s[48:51], s79 offen offset:1024 sc1
    v_exp_f32 v186, v186
    v_exp_f32 v187, v187
    v_cvt_pk_bf16_f32 v77, v182, v183
    v_cvt_pk_bf16_f32 v78, v184, v185
    v_mfma_f32_16x16x32_bf16 v[60:63], v[92:95], v[80:83], v[60:63]
    v_cvt_pk_bf16_f32 v79, v186, v187
    v_exp_f32 v188, v188
    v_exp_f32 v189, v189
    v_mfma_f32_32x32x16_bf16 v[148:163], v[68:71], v[76:79], v[148:163]
    v_exp_f32 v190, v190
    v_exp_f32 v191, v191
    v_exp_f32 v192, v192
    v_cvt_pk_bf16_f32 v80, v188, v189
    v_mfma_f32_16x16x32_bf16 v[64:67], v[92:95], v[76:79], v[64:67]
    v_exp_f32 v193, v193
    v_exp_f32 v194, v194
    v_exp_f32 v195, v195
    v_cvt_pk_bf16_f32 v81, v190, v191
    v_cvt_pk_bf16_f32 v82, v192, v193
    v_cvt_pk_bf16_f32 v83, v194, v195
    v_mfma_f32_32x32x16_bf16 v[180:195], v[36:39], v[20:23], 0
    ds_read_b32 v231, v230
    v_exp_f32 v164, v164
    v_exp_f32 v165, v165
    v_exp_f32 v166, v166
    v_mfma_f32_32x32x16_bf16 v[180:195], v[40:43], v[24:27], v[180:195]
    v_exp_f32 v167, v167
    v_exp_f32 v168, v168
    v_exp_f32 v169, v169
    v_cvt_pk_bf16_f32 v76, v164, v165
    v_mfma_f32_32x32x16_bf16 v[148:163], v[72:75], v[80:83], v[148:163]
    buffer_load_dwordx4 v[220:223], v2, s[48:51], s79 offen offset:2048 sc1
    v_exp_f32 v170, v170
    v_exp_f32 v171, v171
    v_cvt_pk_bf16_f32 v77, v166, v167
    v_cvt_pk_bf16_f32 v78, v168, v169
    v_mfma_f32_16x16x32_bf16 v[64:67], v[92:95], v[80:83], v[64:67]
    v_cvt_pk_bf16_f32 v79, v170, v171
    v_exp_f32 v172, v172
    v_exp_f32 v173, v173
    v_mfma_f32_32x32x16_bf16 v[100:115], v[68:71], v[76:79], v[100:115]
    v_exp_f32 v174, v174
    v_exp_f32 v175, v175
    v_exp_f32 v176, v176
    v_cvt_pk_bf16_f32 v80, v172, v173
    v_mfma_f32_16x16x32_bf16 v[44:47], v[92:95], v[76:79], v[44:47]
    s_waitcnt vmcnt(7)
    v_exp_f32 v177, v177
    v_exp_f32 v178, v178
    v_exp_f32 v179, v179
    v_cvt_pk_bf16_f32 v81, v174, v175
    v_cvt_pk_bf16_f32 v82, v176, v177
    v_cvt_pk_bf16_f32 v83, v178, v179
    v_mfma_f32_32x32x16_bf16 v[164:179], v[52:55], v[12:15], 0
    s_waitcnt lgkmcnt(0)
    v_exp_f32 v180, v180
    v_exp_f32 v181, v181
    v_exp_f32 v182, v182
    v_mfma_f32_32x32x16_bf16 v[164:179], v[56:59], v[16:19], v[164:179]
    v_exp_f32 v183, v183
    v_exp_f32 v184, v184
    v_exp_f32 v185, v185
    v_cvt_pk_bf16_f32 v76, v180, v181
    v_mfma_f32_32x32x16_bf16 v[100:115], v[72:75], v[80:83], v[100:115]
    buffer_load_dwordx4 v[224:227], v2, s[48:51], s79 offen offset:3072 sc1
    v_exp_f32 v186, v186
    v_exp_f32 v187, v187
    v_cvt_pk_bf16_f32 v77, v182, v183
    v_cvt_pk_bf16_f32 v78, v184, v185
    v_mfma_f32_16x16x32_bf16 v[44:47], v[92:95], v[80:83], v[44:47]
    v_readlane_b32 s79, v231, s80
    v_cvt_pk_bf16_f32 v79, v186, v187
    v_exp_f32 v188, v188
    v_exp_f32 v189, v189
    v_mfma_f32_32x32x16_bf16 v[116:131], v[68:71], v[76:79], v[116:131]
    s_cmp_eq_u32 s79, -1
    v_exp_f32 v190, v190
    v_exp_f32 v191, v191
    v_exp_f32 v192, v192
    v_cvt_pk_bf16_f32 v80, v188, v189
    v_mfma_f32_16x16x32_bf16 v[48:51], v[92:95], v[76:79], v[48:51]
    s_cbranch_scc1 L_lwh1
L_loh1:
    v_exp_f32 v193, v193
    v_exp_f32 v194, v194
    v_exp_f32 v195, v195
    v_cvt_pk_bf16_f32 v81, v190, v191
    v_cvt_pk_bf16_f32 v82, v192, v193
    v_cvt_pk_bf16_f32 v83, v194, v195
    v_mfma_f32_32x32x16_bf16 v[180:195], v[52:55], v[28:31], 0
    v_exp_f32 v164, v164
    v_exp_f32 v165, v165
    v_exp_f32 v166, v166
    v_mfma_f32_32x32x16_bf16 v[180:195], v[56:59], v[32:35], v[180:195]
    v_exp_f32 v167, v167
    v_exp_f32 v168, v168
    v_exp_f32 v169, v169
    v_cvt_pk_bf16_f32 v76, v164, v165
    v_mfma_f32_32x32x16_bf16 v[116:131], v[72:75], v[80:83], v[116:131]
    buffer_load_dwordx4 v[36:39], v2, s[44:47], s79 offen offset:0 sc1
    v_exp_f32 v170, v170
    v_exp_f32 v171, v171
    v_cvt_pk_bf16_f32 v77, v166, v167
    v_cvt_pk_bf16_f32 v78, v168, v169
    v_mfma_f32_16x16x32_bf16 v[48:51], v[92:95], v[80:83], v[48:51]
    v_cvt_pk_bf16_f32 v79, v170, v171
    v_exp_f32 v172, v172
    v_exp_f32 v173, v173
    v_mfma_f32_32x32x16_bf16 v[132:147], v[84:87], v[76:79], v[132:147]
    v_exp_f32 v174, v174
    v_exp_f32 v175, v175
    v_exp_f32 v176, v176
    v_cvt_pk_bf16_f32 v80, v172, v173
    v_mfma_f32_16x16x32_bf16 v[60:63], v[92:95], v[76:79], v[60:63]
    v_exp_f32 v177, v177
    v_exp_f32 v178, v178
    v_exp_f32 v179, v179
    v_cvt_pk_bf16_f32 v81, v174, v175
    v_cvt_pk_bf16_f32 v82, v176, v177
    v_cvt_pk_bf16_f32 v83, v178, v179
    v_mfma_f32_32x32x16_bf16 v[164:179], v[52:55], v[4:7], 0
    v_exp_f32 v180, v180
    v_exp_f32 v181, v181
    v_exp_f32 v182, v182
    v_mfma_f32_32x32x16_bf16 v[164:179], v[56:59], v[8:11], v[164:179]
    v_exp_f32 v183, v183
    v_exp_f32 v184, v184
    v_exp_f32 v185, v185
    v_cvt_pk_bf16_f32 v76, v180, v181
    v_mfma_f32_32x32x16_bf16 v[132:147], v[88:91], v[80:83], v[132:147]
    buffer_load_dwordx4 v[40:43], v2, s[44:47], s79 offen offset:1024 sc1
    v_exp_f32 v186, v186
    v_exp_f32 v187, v187
    v_cvt_pk_bf16_f32 v77, v182, v183
    v_cvt_pk_bf16_f32 v78, v184, v185
    v_mfma_f32_16x16x32_bf16 v[60:63], v[92:95], v[80:83], v[60:63]
    v_cvt_pk_bf16_f32 v79, v186, v187
    v_exp_f32 v188, v188
    v_exp_f32 v189, v189
    v_mfma_f32_32x32x16_bf16 v[148:163], v[84:87], v[76:79], v[148:163]
    v_exp_f32 v190, v190
    v_exp_f32 v191, v191
    v_exp_f32 v192, v192
    v_cvt_pk_bf16_f32 v80, v188, v189
    v_mfma_f32_16x16x32_bf16 v[64:67], v[92:95], v[76:79], v[64:67]
    v_exp_f32 v193, v193
    v_exp_f32 v194, v194
    v_exp_f32 v195, v195
    v_cvt_pk_bf16_f32 v81, v190, v191
    v_cvt_pk_bf16_f32 v82, v192, v193
    v_cvt_pk_bf16_f32 v83, v194, v195
    v_mfma_f32_32x32x16_bf16 v[180:195], v[52:55], v[20:23], 0
    v_exp_f32 v164, v164
    v_exp_f32 v165, v165
    v_exp_f32 v166, v166
    v_mfma_f32_32x32x16_bf16 v[180:195], v[56:59], v[24:27], v[180:195]
    v_exp_f32 v167, v167
    v_exp_f32 v168, v168
    v_exp_f32 v169, v169
    v_cvt_pk_bf16_f32 v76, v164, v165
    v_mfma_f32_32x32x16_bf16 v[148:163], v[88:91], v[80:83], v[148:163]
    buffer_load_dwordx4 v[68:71], v2, s[44:47], s79 offen offset:2048 sc1
    v_exp_f32 v170, v170
    v_exp_f32 v171, v171
    v_cvt_pk_bf16_f32 v77, v166, v167
    v_cvt_pk_bf16_f32 v78, v168, v169
    v_mfma_f32_16x16x32_bf16 v[64:67], v[92:95], v[80:83], v[64:67]
    v_cvt_pk_bf16_f32 v79, v170, v171
    v_exp_f32 v172, v172
    v_exp_f32 v173, v173
    v_mfma_f32_32x32x16_bf16 v[100:115], v[84:87], v[76:79], v[100:115]
    v_exp_f32 v174, v174
    v_exp_f32 v175, v175
    v_exp_f32 v176, v176
    v_cvt_pk_bf16_f32 v80, v172, v173
    v_mfma_f32_16x16x32_bf16 v[44:47], v[92:95], v[76:79], v[44:47]
    s_waitcnt vmcnt(7)
    v_exp_f32 v177, v177
    v_exp_f32 v178, v178
    v_exp_f32 v179, v179
    v_cvt_pk_bf16_f32 v81, v174, v175
    v_cvt_pk_bf16_f32 v82, v176, v177
    v_cvt_pk_bf16_f32 v83, v178, v179
    v_mfma_f32_32x32x16_bf16 v[164:179], v[196:199], v[12:15], 0
    v_exp_f32 v180, v180
    v_exp_f32 v181, v181
    v_exp_f32 v182, v182
    v_mfma_f32_32x32x16_bf16 v[164:179], v[200:203], v[16:19], v[164:179]
    v_exp_f32 v183, v183
    v_exp_f32 v184, v184
    v_exp_f32 v185, v185
    v_cvt_pk_bf16_f32 v76, v180, v181
    v_mfma_f32_32x32x16_bf16 v[100:115], v[88:91], v[80:83], v[100:115]
    buffer_load_dwordx4 v[72:75], v2, s[44:47], s79 offen offset:3072 sc1
    v_exp_f32 v186, v186
    v_exp_f32 v187, v187
    v_cvt_pk_bf16_f32 v77, v182, v183
    v_cvt_pk_bf16_f32 v78, v184, v185
    v_mfma_f32_16x16x32_bf16 v[44:47], v[92:95], v[80:83], v[44:47]
    s_sub_u32 s80, s80, 1
    v_cvt_pk_bf16_f32 v79, v186, v187
    v_exp_f32 v188, v188
    v_exp_f32 v189, v189
    v_mfma_f32_32x32x16_bf16 v[116:131], v[84:87], v[76:79], v[116:131]
    v_exp_f32 v190, v190
    v_exp_f32 v191, v191
    v_exp_f32 v192, v192
    v_cvt_pk_bf16_f32 v80, v188, v189
    v_mfma_f32_16x16x32_bf16 v[48:51], v[92:95], v[76:79], v[48:51]
    v_exp_f32 v193, v193
    v_exp_f32 v194, v194
    v_exp_f32 v195, v195
    v_cvt_pk_bf16_f32 v81, v190, v191
    v_cvt_pk_bf16_f32 v82, v192, v193
    v_cvt_pk_bf16_f32 v83, v194, v195
    v_mfma_f32_32x32x16_bf16 v[180:195], v[196:199], v[28:31], 0
    s_branch L_attn
L_attn_done:
    v_mfma_f32_32x32x16_bf16 v[116:131], v[224:227], v[80:83], v[116:131]
    v_mfma_f32_16x16x32_bf16 v[48:51], v[92:95], v[80:83], v[48:51]
    s_mov_b32 s84, 800000
L_px:
    ds_read_b32 v231, v230 offset:16
    s_waitcnt lgkmcnt(0)
    v_cmp_ne_u32 vcc, 1, v231
    s_cbranch_vccz L_pxd
    s_sub_u32 s84, s84, 1
    s_cbranch_scc0 L_px
L_pxd:
    ds_read_b32 v76, v229 offset:0
    ds_read_b128 v[164:167], v228 offset:0
    ds_read_b128 v[168:171], v228 offset:1024
    ds_read_b128 v[172:175], v228 offset:2048
    ds_read_b128 v[176:179], v228 offset:3072
    ds_read_b32 v77, v229 offset:256
    ds_read_b128 v[180:183], v228 offset:4096
    ds_read_b128 v[184:187], v228 offset:5120
    ds_read_b128 v[188:191], v228 offset:6144
    ds_read_b128 v[192:195], v228 offset:7168
    s_waitcnt lgkmcnt(5)
    v_add_f32 v44, v44, v76
    v_pk_add_f32 v[100:101], v[100:101], v[164:165]
    v_pk_add_f32 v[102:103], v[102:103], v[166:167]
    v_pk_add_f32 v[104:105], v[104:105], v[168:169]
    v_pk_add_f32 v[106:107], v[106:107], v[170:171]
    v_pk_add_f32 v[108:109], v[108:109], v[172:173]
    v_pk_add_f32 v[110:111], v[110:111], v[174:175]
    v_pk_add_f32 v[112:113], v[112:113], v[176:177]
    v_pk_add_f32 v[114:115], v[114:115], v[178:179]
    s_waitcnt lgkmcnt(0)
    v_add_f32 v60, v48, v77
    v_pk_add_f32 v[116:117], v[116:117], v[180:181]
    v_pk_add_f32 v[118:119], v[118:119], v[182:183]
    v_pk_add_f32 v[120:121], v[120:121], v[184:185]
    v_pk_add_f32 v[122:123], v[122:123], v[186:187]
    v_pk_add_f32 v[124:125], v[124:125], v[188:189]
    v_pk_add_f32 v[126:127], v[126:127], v[190:191]
    v_pk_add_f32 v[128:129], v[128:129], v[192:193]
    v_pk_add_f32 v[130:131], v[130:131], v[194:195]
    v_mov_b32 v76, v44
    v_mov_b32 v77, v60
    s_nop 0
    v_permlane32_swap_b32 v44, v76
    v_permlane32_swap_b32 v60, v77
    v_mov_b32 v232, 1
    s_mov_b64 exec, 1
    ds_add_u32 v249, v232 offset:8
    s_mov_b64 exec, -1
    v_maximum3_f32 v228, |v100|, |v101|, |v116|
    v_maximum3_f32 v228, |v102|, |v103|, v228
    v_maximum3_f32 v228, |v104|, |v105|, v228
    v_maximum3_f32 v228, |v106|, |v107|, v228
    v_maximum3_f32 v228, |v108|, |v109|, v228
    v_maximum3_f32 v228, |v110|, |v111|, v228
    v_maximum3_f32 v228, |v112|, |v113|, v228
    v_maximum3_f32 v228, |v114|, |v115|, v228
    v_maximum3_f32 v228, |v117|, |v118|, v228
    v_maximum3_f32 v228, |v119|, |v120|, v228
    v_maximum3_f32 v228, |v121|, |v122|, v228
    v_maximum3_f32 v228, |v123|, |v124|, v228
    v_maximum3_f32 v228, |v125|, |v126|, v228
    v_maximum3_f32 v228, |v127|, |v128|, v228
    v_maximum3_f32 v228, |v129|, |v130|, v228
    v_maximum3_f32 v228, |v131|, v228, v228
    v_minimum3_f32 v229, v44, v60, v60
    v_mul_f32 v228, 0x1f800000, v228
    v_cmp_nle_f32 vcc, 0x1f800000, v229
    v_maximum3_f32 v228, v44, v60, v228
    s_mov_b64 s[70:71], vcc
    v_cmp_nge_f32 vcc, 0x5f800000, v228
    s_nop 0
    s_or_b64 s[70:71], s[70:71], vcc
    s_cbranch_scc1 L_exact
L_exact_done:
    v_rcp_f32 v44, v44
    s_nop 0
    v_pk_mul_f32 v[100:101], v[100:101], v[44:45] op_sel_hi:[1,0]
    v_pk_mul_f32 v[102:103], v[102:103], v[44:45] op_sel_hi:[1,0]
    v_pk_mul_f32 v[104:105], v[104:105], v[44:45] op_sel_hi:[1,0]
    v_pk_mul_f32 v[106:107], v[106:107], v[44:45] op_sel_hi:[1,0]
    v_pk_mul_f32 v[108:109], v[108:109], v[44:45] op_sel_hi:[1,0]
    v_pk_mul_f32 v[110:111], v[110:111], v[44:45] op_sel_hi:[1,0]
    v_pk_mul_f32 v[112:113], v[112:113], v[44:45] op_sel_hi:[1,0]
    v_pk_mul_f32 v[114:115], v[114:115], v[44:45] op_sel_hi:[1,0]
    v_cvt_pk_bf16_f32 v100, v100, v101
    v_cvt_pk_bf16_f32 v101, v102, v103
    v_cvt_pk_bf16_f32 v102, v104, v105
    v_cvt_pk_bf16_f32 v103, v106, v107
    v_cvt_pk_bf16_f32 v104, v108, v109
    v_cvt_pk_bf16_f32 v105, v110, v111
    v_cvt_pk_bf16_f32 v106, v112, v113
    v_cvt_pk_bf16_f32 v107, v114, v115
    buffer_store_dwordx4 v[100:103], v2, s[32:35], s78 offen offset:0 sc1
    buffer_store_dwordx4 v[104:107], v2, s[32:35], s78 offen offset:1024 sc1
    s_add_u32 s78, s78, 65536
    v_rcp_f32 v60, v60
    s_nop 0
    v_pk_mul_f32 v[116:117], v[116:117], v[60:61] op_sel_hi:[1,0]
    v_pk_mul_f32 v[118:119], v[118:119], v[60:61] op_sel_hi:[1,0]
    v_pk_mul_f32 v[120:121], v[120:121], v[60:61] op_sel_hi:[1,0]
    v_pk_mul_f32 v[122:123], v[122:123], v[60:61] op_sel_hi:[1,0]
    v_pk_mul_f32 v[124:125], v[124:125], v[60:61] op_sel_hi:[1,0]
    v_pk_mul_f32 v[126:127], v[126:127], v[60:61] op_sel_hi:[1,0]
    v_pk_mul_f32 v[128:129], v[128:129], v[60:61] op_sel_hi:[1,0]
    v_pk_mul_f32 v[130:131], v[130:131], v[60:61] op_sel_hi:[1,0]
    v_cvt_pk_bf16_f32 v116, v116, v117
    v_cvt_pk_bf16_f32 v117, v118, v119
    v_cvt_pk_bf16_f32 v118, v120, v121
    v_cvt_pk_bf16_f32 v119, v122, v123
    v_cvt_pk_bf16_f32 v120, v124, v125
    v_cvt_pk_bf16_f32 v121, v126, v127
    v_cvt_pk_bf16_f32 v122, v128, v129
    v_cvt_pk_bf16_f32 v123, v130, v131
    buffer_store_dwordx4 v[116:119], v2, s[32:35], s78 offen offset:0 sc1
    buffer_store_dwordx4 v[120:123], v2, s[32:35], s78 offen offset:1024 sc1
    v_mov_b32 v132, 0
    v_mov_b32 v133, 0
    v_mov_b32 v134, 0
    v_mov_b32 v135, 0
    v_mov_b32 v136, 0
    v_mov_b32 v137, 0
    v_mov_b32 v138, 0
    v_mov_b32 v139, 0
    v_mov_b32 v140, 0
    v_mov_b32 v141, 0
    v_mov_b32 v142, 0
    v_mov_b32 v143, 0
    v_mov_b32 v144, 0
    v_mov_b32 v145, 0
    v_mov_b32 v146, 0
    v_mov_b32 v147, 0
    v_mov_b32 v148, 0
    v_mov_b32 v149, 0
    v_mov_b32 v150, 0
    v_mov_b32 v151, 0
    v_mov_b32 v152, 0
    v_mov_b32 v153, 0
    v_mov_b32 v154, 0
    v_mov_b32 v155, 0
    v_mov_b32 v156, 0
    v_mov_b32 v157, 0
    v_mov_b32 v158, 0
    v_mov_b32 v159, 0
    v_mov_b32 v160, 0
    v_mov_b32 v161, 0
    v_mov_b32 v162, 0
    v_mov_b32 v163, 0
    v_lshrrev_b32 v244, 5, v1
    v_lshlrev_b32 v244, 9, v244
    v_bfe_u32 v247, v1, 2, 2
    v_lshl_add_u32 v244, v247, 7, v244
    v_and_b32 v247, 1, v1
    v_lshl_add_u32 v244, v247, 5, v244
    v_bfe_u32 v247, v1, 4, 1
    v_lshl_add_u32 v244, v247, 4, v244
    v_bfe_u32 v247, v1, 1, 1
    v_lshl_add_u32 v244, v247, 3, v244
    v_bfe_u32 v247, v1, 3, 1
    v_xor_b32 v247, s67, v247
    v_lshl_add_u32 v244, v247, 6, v244
    s_lshl_b32 s81, s67, 16
    v_add_u32 v244, s81, v244
    v_xor_b32 v245, 64, v244
    v_and_b32 v247, 31, v1
    v_lshlrev_b32 v247, 11, v247
    v_and_b32 v248, 32, v1
    v_add_u32 v246, v248, v247
    s_lshl_b32 s81, s68, 16
    s_lshl_b32 s82, s66, 7
    s_add_u32 s81, s81, s82
    s_lshl_b32 s82, s68, 16
    s_lshl_b32 s83, s67, 15
    s_add_u32 s82, s82, s83
    s_add_u32 s82, s82, 0xf00000
    s_and_b32 s83, s68, 62
    s_lshl_b32 s83, s83, 3
    s_add_u32 s83, s83, s66
    s_lshl_b32 s83, s83, 1
    s_add_u32 s83, s83, s67
    s_lshl_b32 s83, s83, 6
    s_add_u32 s83, s83, 0x2b0000
    s_add_u32 s20, s20, s83
    s_addc_u32 s21, s21, 0
    s_lshl_b32 s72, s62, 12
    s_add_u32 s72, s72, 131072
    v_add_u32 v247, s72, v2
    v_xor_b32 v248, 16384, v247
    s_xor_b32 s72, s72, 16384
    v_and_b32 v232, 31, v1
    v_lshlrev_b32 v232, 6, v232
    v_and_b32 v233, 32, v1
    v_add3_u32 v232, v232, v233, s72
    v_lshrrev_b32 v233, 2, v1
    v_lshlrev_b32 v233, 11, v233
    v_and_or_b32 v233, v2, 48, v233
    s_lshl_b32 s72, s67, 6
    s_add_u32 s81, s81, s72
    s_add_u32 s83, s81, 32768
    s_lshr_b32 s70, s62, 1
    s_lshl_b32 s71, s60, 1
    s_add_u32 s70, s70, s71
    s_lshl_b32 s70, s70, 9
    s_add_u32 s70, s70, s77
    s_lshl_b32 s70, s70, 2
    s_add_u32 s70, s70, 0x2b0000
    v_mov_b32 v228, s63
    v_lshlrev_b32 v229, 7, v1
    s_waitcnt vmcnt(0)
    s_mov_b64 exec, 0xffff
    buffer_store_dword v228, v229, s[32:35], s70 offen sc1
    s_mov_b64 exec, -1
    s_setprio 1
    ds_read_b64_tr_b16 v[188:189], v244 offset:61440
    ds_read_b64_tr_b16 v[190:191], v244 offset:62464
    ds_read_b64_tr_b16 v[192:193], v245 offset:61440
    ds_read_b64_tr_b16 v[194:195], v245 offset:62464
    ds_read_b64_tr_b16 v[196:197], v244 offset:63488
    ds_read_b64_tr_b16 v[198:199], v244 offset:64512
    ds_read_b64_tr_b16 v[200:201], v245 offset:63488
    ds_read_b64_tr_b16 v[202:203], v245 offset:64512
L_proj:
    s_mov_b32 s70, 0x5555
    s_mov_b32 s75, 100000
    s_mov_b32 s76, 0xf0000000
L_cagain:
    s_load_dwordx16 s[4:19], s[20:21], 0 glc
    ds_read_b32 v254, v249 offset:8
    s_waitcnt lgkmcnt(0)
    s_mov_b32 s71, 0
    s_cmp_eq_u32 s19, s63
    s_addc_u32 s71, s71, s71
    s_cmp_eq_u32 s18, s63
    s_addc_u32 s71, s71, s71
    s_cmp_eq_u32 s17, s63
    s_addc_u32 s71, s71, s71
    s_cmp_eq_u32 s16, s63
    s_addc_u32 s71, s71, s71
    s_cmp_eq_u32 s15, s63
    s_addc_u32 s71, s71, s71
    s_cmp_eq_u32 s14, s63
    s_addc_u32 s71, s71, s71
    s_cmp_eq_u32 s13, s63
    s_addc_u32 s71, s71, s71
    s_cmp_eq_u32 s12, s63
    s_addc_u32 s71, s71, s71
    s_cmp_eq_u32 s11, s63
    s_addc_u32 s71, s71, s71
    s_cmp_eq_u32 s10, s63
    s_addc_u32 s71, s71, s71
    s_cmp_eq_u32 s9, s63
    s_addc_u32 s71, s71, s71
    s_cmp_eq_u32 s8, s63
    s_addc_u32 s71, s71, s71
    s_cmp_eq_u32 s7, s63
    s_addc_u32 s71, s71, s71
    s_cmp_eq_u32 s6, s63
    s_addc_u32 s71, s71, s71
    s_cmp_eq_u32 s5, s63
    s_addc_u32 s71, s71, s71
    s_cmp_eq_u32 s4, s63
    s_addc_u32 s71, s71, s71
    s_lshr_b32 s72, s71, 1
    s_and_b32 s71, s71, s72
    s_sub_u32 s75, s75, 1
    s_cselect_b32 s71, -1, s71
    s_and_b32 s71, s71, s70
    s_andn2_b32 s70, s70, s71
    s_and_b32 s77, s71, 0x4000
    s_cbranch_scc0 L_cno7
    s_bitset0_b32 s71, 14
    s_add_u32 s73, s82, 28672
    buffer_load_dwordx4 v[116:119], v2, s[32:35], s73 offen offset:0 sc1
    buffer_load_dwordx4 v[120:123], v2, s[32:35], s73 offen offset:1024 sc1
    buffer_load_dwordx4 v[124:127], v2, s[32:35], s73 offen offset:2048 sc1
    buffer_load_dwordx4 v[128:131], v2, s[32:35], s73 offen offset:3072 sc1
L_cno7:
    s_bcnt1_i32_b32 s74, s71
    s_cbranch_scc1 L_cbatch
    s_cmp_lg_u32 s77, 0
    s_cbranch_scc1 L_cdone
    s_sleep 4
    s_branch L_cagain
L_cbatch:
    s_ff1_i32_b32 s72, s71
    s_bitset0_b32 s71, s72
    s_lshl_b32 s73, s72, 11
    s_add_u32 s73, s73, s82
    s_cmp_lt_i32 s72, 0
    s_cselect_b32 s73, s76, s73
    s_max_i32 s72, s72, 0
    s_lshl_b32 s44, s72, 12
    buffer_load_dwordx4 v[4:7], v2, s[32:35], s73 offen offset:0 sc1
    buffer_load_dwordx4 v[8:11], v2, s[32:35], s73 offen offset:1024 sc1
    buffer_load_dwordx4 v[12:15], v2, s[32:35], s73 offen offset:2048 sc1
    buffer_load_dwordx4 v[16:19], v2, s[32:35], s73 offen offset:3072 sc1
    v_add_u32 v250, s44, v244
    v_add_u32 v251, s44, v245
    ds_read_b64_tr_b16 v[168:169], v251 offset:0
    ds_read_b64_tr_b16 v[170:171], v251 offset:1024
    ds_read_b64_tr_b16 v[164:165], v250 offset:0
    ds_read_b64_tr_b16 v[166:167], v250 offset:1024
    ds_read_b64_tr_b16 v[176:177], v251 offset:2048
    ds_read_b64_tr_b16 v[178:179], v251 offset:3072
    ds_read_b64_tr_b16 v[172:173], v250 offset:2048
    ds_read_b64_tr_b16 v[174:175], v250 offset:3072
    s_ff1_i32_b32 s72, s71
    s_bitset0_b32 s71, s72
    s_lshl_b32 s73, s72, 11
    s_add_u32 s73, s73, s82
    s_cmp_lt_i32 s72, 0
    s_cselect_b32 s73, s76, s73
    s_max_i32 s72, s72, 0
    s_lshl_b32 s45, s72, 12
    v_add_u32 v252, s45, v244
    v_add_u32 v253, s45, v245
    s_waitcnt vmcnt(3) lgkmcnt(4)
    v_mfma_f32_32x32x16_bf16 v[148:163], v[168:171], v[4:7], v[148:163]
    ds_read_b64_tr_b16 v[184:185], v251 offset:4096
    ds_read_b64_tr_b16 v[186:187], v251 offset:5120
    buffer_load_dwordx4 v[20:23], v2, s[32:35], s73 offen offset:0 sc1
    v_mfma_f32_32x32x16_bf16 v[132:147], v[164:167], v[4:7], v[132:147]
    ds_read_b64_tr_b16 v[180:181], v250 offset:4096
    ds_read_b64_tr_b16 v[182:183], v250 offset:5120
    s_waitcnt vmcnt(3) lgkmcnt(4)
    v_mfma_f32_32x32x16_bf16 v[148:163], v[176:179], v[8:11], v[148:163]
    ds_read_b64_tr_b16 v[168:169], v251 offset:6144
    ds_read_b64_tr_b16 v[170:171], v251 offset:7168
    buffer_load_dwordx4 v[24:27], v2, s[32:35], s73 offen offset:1024 sc1
    v_mfma_f32_32x32x16_bf16 v[132:147], v[172:175], v[8:11], v[132:147]
    ds_read_b64_tr_b16 v[164:165], v250 offset:6144
    ds_read_b64_tr_b16 v[166:167], v250 offset:7168
    s_waitcnt vmcnt(3) lgkmcnt(4)
    v_mfma_f32_32x32x16_bf16 v[148:163], v[184:187], v[12:15], v[148:163]
    ds_read_b64_tr_b16 v[176:177], v253 offset:0
    ds_read_b64_tr_b16 v[178:179], v253 offset:1024
    buffer_load_dwordx4 v[28:31], v2, s[32:35], s73 offen offset:2048 sc1
    v_mfma_f32_32x32x16_bf16 v[132:147], v[180:183], v[12:15], v[132:147]
    ds_read_b64_tr_b16 v[172:173], v252 offset:0
    ds_read_b64_tr_b16 v[174:175], v252 offset:1024
    s_waitcnt vmcnt(3) lgkmcnt(4)
    v_mfma_f32_32x32x16_bf16 v[148:163], v[168:171], v[16:19], v[148:163]
    ds_read_b64_tr_b16 v[184:185], v253 offset:2048
    ds_read_b64_tr_b16 v[186:187], v253 offset:3072
    buffer_load_dwordx4 v[32:35], v2, s[32:35], s73 offen offset:3072 sc1
    v_mfma_f32_32x32x16_bf16 v[132:147], v[164:167], v[16:19], v[132:147]
    ds_read_b64_tr_b16 v[180:181], v252 offset:2048
    ds_read_b64_tr_b16 v[182:183], v252 offset:3072
    s_cmp_eq_u32 s74, 1
    s_cbranch_scc1 L_cdone
    s_ff1_i32_b32 s72, s71
    s_bitset0_b32 s71, s72
    s_lshl_b32 s73, s72, 11
    s_add_u32 s73, s73, s82
    s_cmp_lt_i32 s72, 0
    s_cselect_b32 s73, s76, s73
    s_max_i32 s72, s72, 0
    s_lshl_b32 s46, s72, 12
    v_add_u32 v250, s46, v244
    v_add_u32 v251, s46, v245
    s_waitcnt vmcnt(3) lgkmcnt(4)
    v_mfma_f32_32x32x16_bf16 v[148:163], v[176:179], v[20:23], v[148:163]
    ds_read_b64_tr_b16 v[168:169], v253 offset:4096
    ds_read_b64_tr_b16 v[170:171], v253 offset:5120
    buffer_load_dwordx4 v[36:39], v2, s[32:35], s73 offen offset:0 sc1
    v_mfma_f32_32x32x16_bf16 v[132:147], v[172:175], v[20:23], v[132:147]
    ds_read_b64_tr_b16 v[164:165], v252 offset:4096
    ds_read_b64_tr_b16 v[166:167], v252 offset:5120
    s_waitcnt vmcnt(3) lgkmcnt(4)
    v_mfma_f32_32x32x16_bf16 v[148:163], v[184:187], v[24:27], v[148:163]
    ds_read_b64_tr_b16 v[176:177], v253 offset:6144
    ds_read_b64_tr_b16 v[178:179], v253 offset:7168
    buffer_load_dwordx4 v[40:43], v2, s[32:35], s73 offen offset:1024 sc1
    v_mfma_f32_32x32x16_bf16 v[132:147], v[180:183], v[24:27], v[132:147]
    ds_read_b64_tr_b16 v[172:173], v252 offset:6144
    ds_read_b64_tr_b16 v[174:175], v252 offset:7168
    s_waitcnt vmcnt(3) lgkmcnt(4)
    v_mfma_f32_32x32x16_bf16 v[148:163], v[168:171], v[28:31], v[148:163]
    ds_read_b64_tr_b16 v[184:185], v251 offset:0
    ds_read_b64_tr_b16 v[186:187], v251 offset:1024
    buffer_load_dwordx4 v[44:47], v2, s[32:35], s73 offen offset:2048 sc1
    v_mfma_f32_32x32x16_bf16 v[132:147], v[164:167], v[28:31], v[132:147]
    ds_read_b64_tr_b16 v[180:181], v250 offset:0
    ds_read_b64_tr_b16 v[182:183], v250 offset:1024
    s_waitcnt vmcnt(3) lgkmcnt(4)
    v_mfma_f32_32x32x16_bf16 v[148:163], v[176:179], v[32:35], v[148:163]
    ds_read_b64_tr_b16 v[168:169], v251 offset:2048
    ds_read_b64_tr_b16 v[170:171], v251 offset:3072
    buffer_load_dwordx4 v[48:51], v2, s[32:35], s73 offen offset:3072 sc1
    v_mfma_f32_32x32x16_bf16 v[132:147], v[172:175], v[32:35], v[132:147]
    ds_read_b64_tr_b16 v[164:165], v250 offset:2048
    ds_read_b64_tr_b16 v[166:167], v250 offset:3072
    s_cmp_eq_u32 s74, 2
    s_cbranch_scc1 L_cdone
    s_ff1_i32_b32 s72, s71
    s_bitset0_b32 s71, s72
    s_lshl_b32 s73, s72, 11
    s_add_u32 s73, s73, s82
    s_cmp_lt_i32 s72, 0
    s_cselect_b32 s73, s76, s73
    s_max_i32 s72, s72, 0
    s_lshl_b32 s47, s72, 12
    v_add_u32 v252, s47, v244
    v_add_u32 v253, s47, v245
    s_waitcnt vmcnt(3) lgkmcnt(4)
    v_mfma_f32_32x32x16_bf16 v[148:163], v[184:187], v[36:39], v[148:163]
    ds_read_b64_tr_b16 v[176:177], v251 offset:4096
    ds_read_b64_tr_b16 v[178:179], v251 offset:5120
    buffer_load_dwordx4 v[52:55], v2, s[32:35], s73 offen offset:0 sc1
    v_mfma_f32_32x32x16_bf16 v[132:147], v[180:183], v[36:39], v[132:147]
    ds_read_b64_tr_b16 v[172:173], v250 offset:4096
    ds_read_b64_tr_b16 v[174:175], v250 offset:5120
    s_waitcnt vmcnt(3) lgkmcnt(4)
    v_mfma_f32_32x32x16_bf16 v[148:163], v[168:171], v[40:43], v[148:163]
    ds_read_b64_tr_b16 v[184:185], v251 offset:6144
    ds_read_b64_tr_b16 v[186:187], v251 offset:7168
    buffer_load_dwordx4 v[56:59], v2, s[32:35], s73 offen offset:1024 sc1
    v_mfma_f32_32x32x16_bf16 v[132:147], v[164:167], v[40:43], v[132:147]
    ds_read_b64_tr_b16 v[180:181], v250 offset:6144
    ds_read_b64_tr_b16 v[182:183], v250 offset:7168
    s_waitcnt vmcnt(3) lgkmcnt(4)
    v_mfma_f32_32x32x16_bf16 v[148:163], v[176:179], v[44:47], v[148:163]
    ds_read_b64_tr_b16 v[168:169], v253 offset:0
    ds_read_b64_tr_b16 v[170:171], v253 offset:1024
    buffer_load_dwordx4 v[60:63], v2, s[32:35], s73 offen offset:2048 sc1
    v_mfma_f32_32x32x16_bf16 v[132:147], v[172:175], v[44:47], v[132:147]
    ds_read_b64_tr_b16 v[164:165], v252 offset:0
    ds_read_b64_tr_b16 v[166:167], v252 offset:1024
    s_waitcnt vmcnt(3) lgkmcnt(4)
    v_mfma_f32_32x32x16_bf16 v[148:163], v[184:187], v[48:51], v[148:163]
    ds_read_b64_tr_b16 v[176:177], v253 offset:2048
    ds_read_b64_tr_b16 v[178:179], v253 offset:3072
    buffer_load_dwordx4 v[64:67], v2, s[32:35], s73 offen offset:3072 sc1
    v_mfma_f32_32x32x16_bf16 v[132:147], v[180:183], v[48:51], v[132:147]
    ds_read_b64_tr_b16 v[172:173], v252 offset:2048
    ds_read_b64_tr_b16 v[174:175], v252 offset:3072
    s_cmp_eq_u32 s74, 3
    s_cbranch_scc1 L_cdone
    s_ff1_i32_b32 s72, s71
    s_bitset0_b32 s71, s72
    s_lshl_b32 s73, s72, 11
    s_add_u32 s73, s73, s82
    s_cmp_lt_i32 s72, 0
    s_cselect_b32 s73, s76, s73
    s_max_i32 s72, s72, 0
    s_lshl_b32 s48, s72, 12
    v_add_u32 v250, s48, v244
    v_add_u32 v251, s48, v245
    s_waitcnt vmcnt(3) lgkmcnt(4)
    v_mfma_f32_32x32x16_bf16 v[148:163], v[168:171], v[52:55], v[148:163]
    ds_read_b64_tr_b16 v[184:185], v253 offset:4096
    ds_read_b64_tr_b16 v[186:187], v253 offset:5120
    buffer_load_dwordx4 v[68:71], v2, s[32:35], s73 offen offset:0 sc1
    v_mfma_f32_32x32x16_bf16 v[132:147], v[164:167], v[52:55], v[132:147]
    ds_read_b64_tr_b16 v[180:181], v252 offset:4096
    ds_read_b64_tr_b16 v[182:183], v252 offset:5120
    s_waitcnt vmcnt(3) lgkmcnt(4)
    v_mfma_f32_32x32x16_bf16 v[148:163], v[176:179], v[56:59], v[148:163]
    ds_read_b64_tr_b16 v[168:169], v253 offset:6144
    ds_read_b64_tr_b16 v[170:171], v253 offset:7168
    buffer_load_dwordx4 v[72:75], v2, s[32:35], s73 offen offset:1024 sc1
    v_mfma_f32_32x32x16_bf16 v[132:147], v[172:175], v[56:59], v[132:147]
    ds_read_b64_tr_b16 v[164:165], v252 offset:6144
    ds_read_b64_tr_b16 v[166:167], v252 offset:7168
    s_waitcnt vmcnt(3) lgkmcnt(4)
    v_mfma_f32_32x32x16_bf16 v[148:163], v[184:187], v[60:63], v[148:163]
    ds_read_b64_tr_b16 v[176:177], v251 offset:0
    ds_read_b64_tr_b16 v[178:179], v251 offset:1024
    buffer_load_dwordx4 v[76:79], v2, s[32:35], s73 offen offset:2048 sc1
    v_mfma_f32_32x32x16_bf16 v[132:147], v[180:183], v[60:63], v[132:147]
    ds_read_b64_tr_b16 v[172:173], v250 offset:0
    ds_read_b64_tr_b16 v[174:175], v250 offset:1024
    s_waitcnt vmcnt(3) lgkmcnt(4)
    v_mfma_f32_32x32x16_bf16 v[148:163], v[168:171], v[64:67], v[148:163]
    ds_read_b64_tr_b16 v[184:185], v251 offset:2048
    ds_read_b64_tr_b16 v[186:187], v251 offset:3072
    buffer_load_dwordx4 v[80:83], v2, s[32:35], s73 offen offset:3072 sc1
    v_mfma_f32_32x32x16_bf16 v[132:147], v[164:167], v[64:67], v[132:147]
    ds_read_b64_tr_b16 v[180:181], v250 offset:2048
    ds_read_b64_tr_b16 v[182:183], v250 offset:3072
    s_cmp_eq_u32 s74, 4
    s_cbranch_scc1 L_cdone
    s_ff1_i32_b32 s72, s71
    s_bitset0_b32 s71, s72
    s_lshl_b32 s73, s72, 11
    s_add_u32 s73, s73, s82
    s_cmp_lt_i32 s72, 0
    s_cselect_b32 s73, s76, s73
    s_max_i32 s72, s72, 0
    s_lshl_b32 s49, s72, 12
    v_add_u32 v252, s49, v244
    v_add_u32 v253, s49, v245
    s_waitcnt vmcnt(3) lgkmcnt(4)
    v_mfma_f32_32x32x16_bf16 v[148:163], v[176:179], v[68:71], v[148:163]
    ds_read_b64_tr_b16 v[168:169], v251 offset:4096
    ds_read_b64_tr_b16 v[170:171], v251 offset:5120
    buffer_load_dwordx4 v[84:87], v2, s[32:35], s73 offen offset:0 sc1
    v_mfma_f32_32x32x16_bf16 v[132:147], v[172:175], v[68:71], v[132:147]
    ds_read_b64_tr_b16 v[164:165], v250 offset:4096
    ds_read_b64_tr_b16 v[166:167], v250 offset:5120
    s_waitcnt vmcnt(3) lgkmcnt(4)
    v_mfma_f32_32x32x16_bf16 v[148:163], v[184:187], v[72:75], v[148:163]
    ds_read_b64_tr_b16 v[176:177], v251 offset:6144
    ds_read_b64_tr_b16 v[178:179], v251 offset:7168
    buffer_load_dwordx4 v[88:91], v2, s[32:35], s73 offen offset:1024 sc1
    v_mfma_f32_32x32x16_bf16 v[132:147], v[180:183], v[72:75], v[132:147]
    ds_read_b64_tr_b16 v[172:173], v250 offset:6144
    ds_read_b64_tr_b16 v[174:175], v250 offset:7168
    s_waitcnt vmcnt(3) lgkmcnt(4)
    v_mfma_f32_32x32x16_bf16 v[148:163], v[168:171], v[76:79], v[148:163]
    ds_read_b64_tr_b16 v[184:185], v253 offset:0
    ds_read_b64_tr_b16 v[186:187], v253 offset:1024
    buffer_load_dwordx4 v[92:95], v2, s[32:35], s73 offen offset:2048 sc1
    v_mfma_f32_32x32x16_bf16 v[132:147], v[164:167], v[76:79], v[132:147]
    ds_read_b64_tr_b16 v[180:181], v252 offset:0
    ds_read_b64_tr_b16 v[182:183], v252 offset:1024
    s_waitcnt vmcnt(3) lgkmcnt(4)
    v_mfma_f32_32x32x16_bf16 v[148:163], v[176:179], v[80:83], v[148:163]
    ds_read_b64_tr_b16 v[168:169], v253 offset:2048
    ds_read_b64_tr_b16 v[170:171], v253 offset:3072
    buffer_load_dwordx4 v[96:99], v2, s[32:35], s73 offen offset:3072 sc1
    v_mfma_f32_32x32x16_bf16 v[132:147], v[172:175], v[80:83], v[132:147]
    ds_read_b64_tr_b16 v[164:165], v252 offset:2048
    ds_read_b64_tr_b16 v[166:167], v252 offset:3072
    s_cmp_eq_u32 s74, 5
    s_cbranch_scc1 L_cdone
    s_ff1_i32_b32 s72, s71
    s_bitset0_b32 s71, s72
    s_lshl_b32 s73, s72, 11
    s_add_u32 s73, s73, s82
    s_cmp_lt_i32 s72, 0
    s_cselect_b32 s73, s76, s73
    s_max_i32 s72, s72, 0
    s_lshl_b32 s50, s72, 12
    v_add_u32 v250, s50, v244
    v_add_u32 v251, s50, v245
    s_waitcnt vmcnt(3) lgkmcnt(4)
    v_mfma_f32_32x32x16_bf16 v[148:163], v[184:187], v[84:87], v[148:163]
    ds_read_b64_tr_b16 v[176:177], v253 offset:4096
    ds_read_b64_tr_b16 v[178:179], v253 offset:5120
    buffer_load_dwordx4 v[100:103], v2, s[32:35], s73 offen offset:0 sc1
    v_mfma_f32_32x32x16_bf16 v[132:147], v[180:183], v[84:87], v[132:147]
    ds_read_b64_tr_b16 v[172:173], v252 offset:4096
    ds_read_b64_tr_b16 v[174:175], v252 offset:5120
    s_waitcnt vmcnt(3) lgkmcnt(4)
    v_mfma_f32_32x32x16_bf16 v[148:163], v[168:171], v[88:91], v[148:163]
    ds_read_b64_tr_b16 v[184:185], v253 offset:6144
    ds_read_b64_tr_b16 v[186:187], v253 offset:7168
    buffer_load_dwordx4 v[104:107], v2, s[32:35], s73 offen offset:1024 sc1
    v_mfma_f32_32x32x16_bf16 v[132:147], v[164:167], v[88:91], v[132:147]
    ds_read_b64_tr_b16 v[180:181], v252 offset:6144
    ds_read_b64_tr_b16 v[182:183], v252 offset:7168
    s_waitcnt vmcnt(3) lgkmcnt(4)
    v_mfma_f32_32x32x16_bf16 v[148:163], v[176:179], v[92:95], v[148:163]
    ds_read_b64_tr_b16 v[168:169], v251 offset:0
    ds_read_b64_tr_b16 v[170:171], v251 offset:1024
    buffer_load_dwordx4 v[108:111], v2, s[32:35], s73 offen offset:2048 sc1
    v_mfma_f32_32x32x16_bf16 v[132:147], v[172:175], v[92:95], v[132:147]
    ds_read_b64_tr_b16 v[164:165], v250 offset:0
    ds_read_b64_tr_b16 v[166:167], v250 offset:1024
    s_waitcnt vmcnt(3) lgkmcnt(4)
    v_mfma_f32_32x32x16_bf16 v[148:163], v[184:187], v[96:99], v[148:163]
    ds_read_b64_tr_b16 v[176:177], v251 offset:2048
    ds_read_b64_tr_b16 v[178:179], v251 offset:3072
    buffer_load_dwordx4 v[112:115], v2, s[32:35], s73 offen offset:3072 sc1
    v_mfma_f32_32x32x16_bf16 v[132:147], v[180:183], v[96:99], v[132:147]
    ds_read_b64_tr_b16 v[172:173], v250 offset:2048
    ds_read_b64_tr_b16 v[174:175], v250 offset:3072
    s_cmp_eq_u32 s74, 6
    s_cbranch_scc1 L_cdone
    s_waitcnt vmcnt(3) lgkmcnt(4)
    v_mfma_f32_32x32x16_bf16 v[148:163], v[168:171], v[100:103], v[148:163]
    ds_read_b64_tr_b16 v[184:185], v251 offset:4096
    ds_read_b64_tr_b16 v[186:187], v251 offset:5120
    v_mfma_f32_32x32x16_bf16 v[132:147], v[164:167], v[100:103], v[132:147]
    ds_read_b64_tr_b16 v[180:181], v250 offset:4096
    ds_read_b64_tr_b16 v[182:183], v250 offset:5120
    s_waitcnt vmcnt(2) lgkmcnt(4)
    v_mfma_f32_32x32x16_bf16 v[148:163], v[176:179], v[104:107], v[148:163]
    ds_read_b64_tr_b16 v[168:169], v251 offset:6144
    ds_read_b64_tr_b16 v[170:171], v251 offset:7168
    v_mfma_f32_32x32x16_bf16 v[132:147], v[172:175], v[104:107], v[132:147]
    ds_read_b64_tr_b16 v[164:165], v250 offset:6144
    ds_read_b64_tr_b16 v[166:167], v250 offset:7168
    s_waitcnt vmcnt(1) lgkmcnt(4)
    v_mfma_f32_32x32x16_bf16 v[148:163], v[184:187], v[108:111], v[148:163]
    v_mfma_f32_32x32x16_bf16 v[132:147], v[180:183], v[108:111], v[132:147]
    s_waitcnt vmcnt(0) lgkmcnt(0)
    v_mfma_f32_32x32x16_bf16 v[148:163], v[168:171], v[112:115], v[148:163]
    v_mfma_f32_32x32x16_bf16 v[132:147], v[164:167], v[112:115], v[132:147]
L_cdone:
    s_cmp_eq_u32 s77, 0
    s_cbranch_scc1 L_cnext
    v_add_u32 v250, 57344, v244
    v_add_u32 v251, 57344, v245
    ds_read_b64_tr_b16 v[168:169], v251 offset:0
    ds_read_b64_tr_b16 v[170:171], v251 offset:1024
    ds_read_b64_tr_b16 v[164:165], v250 offset:0
    ds_read_b64_tr_b16 v[166:167], v250 offset:1024
    ds_read_b64_tr_b16 v[176:177], v251 offset:2048
    ds_read_b64_tr_b16 v[178:179], v251 offset:3072
    ds_read_b64_tr_b16 v[172:173], v250 offset:2048
    ds_read_b64_tr_b16 v[174:175], v250 offset:3072
    s_waitcnt vmcnt(0)
    v_mfma_f32_32x32x16_bf16 v[148:163], v[192:195], v[124:127], v[148:163]
    v_mfma_f32_32x32x16_bf16 v[132:147], v[188:191], v[124:127], v[132:147]
    v_mfma_f32_32x32x16_bf16 v[148:163], v[200:203], v[128:131], v[148:163]
    v_mfma_f32_32x32x16_bf16 v[132:147], v[196:199], v[128:131], v[132:147]
    s_waitcnt lgkmcnt(0)
    v_mfma_f32_32x32x16_bf16 v[148:163], v[168:171], v[116:119], v[148:163]
    v_mfma_f32_32x32x16_bf16 v[132:147], v[164:167], v[116:119], v[132:147]
    v_mfma_f32_32x32x16_bf16 v[148:163], v[176:179], v[120:123], v[148:163]
    v_mfma_f32_32x32x16_bf16 v[132:147], v[172:175], v[120:123], v[132:147]
L_cnext:
    s_cmp_lg_u32 s70, 0
    s_cbranch_scc1 L_cagain
    s_mov_b32 s84, 800000
L_lw5:
    s_waitcnt lgkmcnt(0)
    v_cmp_ne_u32 vcc, 4, v254
    s_cbranch_vccz L_lwd6
    s_sub_u32 s84, s84, 1
    s_cbranch_scc1 L_lwd6
    s_sleep 1
    ds_read_b32 v254, v249 offset:8
    s_branch L_lw5
L_lwd6:
    s_nop 4
    ds_write_b128 v247, v[148:151] offset:0
    ds_write_b128 v247, v[152:155] offset:1024
    ds_write_b128 v247, v[156:159] offset:2048
    ds_write_b128 v247, v[160:163] offset:3072
    s_waitcnt lgkmcnt(0)
    s_barrier
    ds_read_b128 v[4:7], v248 offset:0
    ds_read_b128 v[8:11], v248 offset:1024
    ds_read_b128 v[12:15], v248 offset:2048
    ds_read_b128 v[16:19], v248 offset:3072
    s_waitcnt lgkmcnt(3)
    v_pk_add_f32 v[132:133], v[132:133], v[4:5]
    v_pk_add_f32 v[134:135], v[134:135], v[6:7]
    v_cvt_pk_bf16_f32 v132, v132, v133
    v_cvt_pk_bf16_f32 v133, v134, v135
    s_waitcnt lgkmcnt(2)
    v_pk_add_f32 v[136:137], v[136:137], v[8:9]
    v_pk_add_f32 v[138:139], v[138:139], v[10:11]
    v_cvt_pk_bf16_f32 v134, v136, v137
    v_cvt_pk_bf16_f32 v135, v138, v139
    s_waitcnt lgkmcnt(1)
    v_pk_add_f32 v[140:141], v[140:141], v[12:13]
    v_pk_add_f32 v[142:143], v[142:143], v[14:15]
    v_cvt_pk_bf16_f32 v136, v140, v141
    v_cvt_pk_bf16_f32 v137, v142, v143
    s_waitcnt lgkmcnt(0)
    v_pk_add_f32 v[144:145], v[144:145], v[16:17]
    v_pk_add_f32 v[146:147], v[146:147], v[18:19]
    v_cvt_pk_bf16_f32 v138, v144, v145
    v_cvt_pk_bf16_f32 v139, v146, v147
    ds_write_b128 v232, v[132:135] offset:0
    ds_write_b128 v232, v[136:139] offset:16
    s_waitcnt lgkmcnt(0)
    ds_read_b128 v[4:7], v248 offset:0
    ds_read_b128 v[8:11], v248 offset:1024
    s_waitcnt lgkmcnt(1)
    buffer_store_dwordx4 v[4:7], v233, s[40:43], s81 offen
    s_waitcnt lgkmcnt(0)
    buffer_store_dwordx4 v[8:11], v233, s[40:43], s83 offen
L_end:
    s_endpgm
L_helper:
    s_sub_u32 s76, s62, 4
    s_cmp_gt_u32 s61, 3
    s_subb_u32 s3, s61, 0
    s_cmp_gt_u32 s61, 11
    s_subb_u32 s3, s3, 0
    s_and_b32 s75, s61, 7
    s_cmp_eq_u32 s75, 3
    s_cselect_b32 s3, 14, s3
    s_lshl_b32 s3, s3, 4
    s_add_u32 s3, s3, s60
    s_lshl_b32 s75, s3, 2
    s_add_u32 s75, s75, s76
    s_lshl_b32 s77, s60, 4
    s_add_u32 s77, s77, s61
    s_lshl_b32 s77, s77, 2
    s_add_u32 s77, s77, s76
    s_lshl_b32 s77, s77, 1
    s_and_b32 s55, s60, 7
    s_mul_i32 s70, s55, 43
    s_lshr_b32 s70, s70, 7
    s_mul_i32 s70, s70, 3
    s_sub_u32 s70, s55, s70
    s_mul_i32 s70, s70, 40960
    s_lshl_b32 s71, s76, 11
    s_add_u32 s70, s70, s71
    s_add_u32 s70, s70, 16384
    v_and_b32 v214, 16, v1
    v_lshlrev_b32 v172, 2, v214
    v_xor_b32 v172, v172, v2
    v_add_u32 v172, s70, v172
    v_xor_b32 v175, 32, v172
    v_and_b32 v173, 7, v1
    v_lshlrev_b32 v173, 4, v173
    v_lshl_add_u32 v173, v214, 3, v173
    s_mul_i32 s54, s60, 24576
    s_lshl_b32 s71, s76, 13
    s_add_u32 s54, s54, s71
    s_lshl_b32 s71, s61, 9
    s_add_u32 s54, s54, s71
    s_add_u32 s54, s54, 0x240000
    s_cmp_eq_u32 s76, 3
    s_cselect_b32 s55, 99, s55
    v_and_b32 v214, 1, v1
    v_lshlrev_b32 v214, 4, v214
    v_mov_b32 v215, 0xffff
    v_lshlrev_b32 v215, v214, v215
    v_bfe_u32 v214, v1, 1, 3
    v_cmp_eq_u32 vcc, 0, v214
    s_nop 1
    v_cndmask_b32 v210, 0, v215, vcc
    v_cmp_eq_u32 vcc, 1, v214
    s_nop 1
    v_cndmask_b32 v211, 0, v215, vcc
    v_cmp_eq_u32 vcc, 2, v214
    s_nop 1
    v_cndmask_b32 v212, 0, v215, vcc
    v_cmp_eq_u32 vcc, 3, v214
    s_nop 1
    v_cndmask_b32 v213, 0, v215, vcc
    v_and_b32 v124, 0x3f803f80, v210
    v_and_b32 v125, 0x3f803f80, v211
    v_and_b32 v126, 0x3f803f80, v212
    v_and_b32 v127, 0x3f803f80, v213
    s_waitcnt lgkmcnt(0)
    s_load_dword s22, s[20:21], 0x6000
    s_getpc_b64 s[50:51]
L_here:
    s_lshr_b32 s70, s2, 3
    s_lshl_b32 s70, s70, 2
    s_add_u32 s70, s70, s76
    s_lshl_b32 s70, s70, 8
    s_min_u32 s70, s70, L_codeend-parallel_sum__mha_block__moe_arch_mod__prompt_kernel-256
    s_sub_u32 s70, s70, L_here-parallel_sum__mha_block__moe_arch_mod__prompt_kernel
    s_ashr_i32 s71, s70, 31
    s_add_u32 s50, s50, s70
    s_addc_u32 s51, s51, s71
    s_load_dword s85, s[50:51], 0
    s_load_dword s85, s[50:51], 128
    s_mov_b32 s24, s4
    s_and_b32 s25, s5, 0xffff
    s_mov_b32 s26, 0x400000
    s_mov_b32 s27, 0x00020000
    s_mov_b32 s44, s12
    s_and_b32 s45, s13, 0xffff
    s_mov_b32 s46, 0x800
    s_mov_b32 s47, 0x00020000
    s_mov_b32 s32, s20
    s_and_b32 s33, s21, 0xffff
    s_mov_b32 s34, 0x10000000
    s_mov_b32 s35, 0x00020000
    s_mov_b32 s36, s8
    s_and_b32 s37, s9, 0xffff
    s_mov_b32 s38, 0x200000
    s_mov_b32 s39, 0x00020000
    s_mov_b32 s40, s10
    s_and_b32 s41, s11, 0xffff
    s_mov_b32 s42, 0x400000
    s_mov_b32 s43, 0x00020000
    s_setprio 1
    s_lshl_b32 s70, s77, 11
    buffer_load_dwordx4 v[4:7], v2, s[24:27], s70 offen offset:0
    buffer_load_dwordx4 v[8:11], v2, s[24:27], s70 offen offset:1024
    buffer_load_dwordx4 v[12:15], v2, s[24:27], s70 offen offset:2048
    buffer_load_dwordx4 v[16:19], v2, s[24:27], s70 offen offset:3072
    buffer_load_dwordx4 v[20:23], v2, s[44:47], 0 offen offset:0
    buffer_load_dwordx4 v[24:27], v2, s[44:47], 0 offen offset:1024
    s_setprio 0
    s_waitcnt lgkmcnt(0)
    s_mul_i32 s63, s22, 0x9E3779B1
    s_add_u32 s63, s63, 0x7F4A7C15
    s_barrier
    s_waitcnt vmcnt(0)
    s_cmp_lg_u32 s55, 0
    s_cbranch_scc1 L_nocs15
    s_call_b64 s[52:53], L_colsum
L_nocs15:
    v_and_b32 v61, s64, v4
    v_lshlrev_b32 v60, 16, v4
    v_and_b32 v63, s64, v5
    v_lshlrev_b32 v62, 16, v5
    v_and_b32 v65, s64, v6
    v_lshlrev_b32 v64, 16, v6
    v_and_b32 v67, s64, v7
    v_lshlrev_b32 v66, 16, v7
    v_and_b32 v69, s64, v8
    v_lshlrev_b32 v68, 16, v8
    v_and_b32 v71, s64, v9
    v_lshlrev_b32 v70, 16, v9
    v_and_b32 v73, s64, v10
    v_lshlrev_b32 v72, 16, v10
    v_and_b32 v75, s64, v11
    v_lshlrev_b32 v74, 16, v11
    v_and_b32 v77, s64, v12
    v_lshlrev_b32 v76, 16, v12
    v_and_b32 v79, s64, v13
    v_lshlrev_b32 v78, 16, v13
    v_and_b32 v81, s64, v14
    v_lshlrev_b32 v80, 16, v14
    v_and_b32 v83, s64, v15
    v_lshlrev_b32 v82, 16, v15
    v_and_b32 v85, s64, v16
    v_lshlrev_b32 v84, 16, v16
    v_and_b32 v87, s64, v17
    v_lshlrev_b32 v86, 16, v17
    v_and_b32 v89, s64, v18
    v_lshlrev_b32 v88, 16, v18
    v_and_b32 v91, s64, v19
    v_lshlrev_b32 v90, 16, v19
    v_and_b32 v93, s64, v20
    v_lshlrev_b32 v92, 16, v20
    v_and_b32 v95, s64, v21
    v_lshlrev_b32 v94, 16, v21
    v_and_b32 v97, s64, v22
    v_lshlrev_b32 v96, 16, v22
    v_and_b32 v99, s64, v23
    v_lshlrev_b32 v98, 16, v23
    v_and_b32 v101, s64, v24
    v_lshlrev_b32 v100, 16, v24
    v_and_b32 v103, s64, v25
    v_lshlrev_b32 v102, 16, v25
    v_and_b32 v105, s64, v26
    v_lshlrev_b32 v104, 16, v26
    v_and_b32 v107, s64, v27
    v_lshlrev_b32 v106, 16, v27
    v_add_f32 v108, v60, v61
    v_mul_f32 v110, v60, v92
    v_add_f32 v109, v76, v77
    v_mul_f32 v111, v76, v92
    v_add_f32 v112, v92, v93
    v_fmac_f32 v110, v61, v93
    v_fmac_f32 v111, v77, v93
    v_add_f32 v108, v108, v62
    v_fmac_f32 v110, v62, v94
    v_add_f32 v109, v109, v78
    v_fmac_f32 v111, v78, v94
    v_add_f32 v112, v112, v94
    v_add_f32 v108, v108, v63
    v_fmac_f32 v110, v63, v95
    v_add_f32 v109, v109, v79
    v_fmac_f32 v111, v79, v95
    v_add_f32 v112, v112, v95
    v_add_f32 v108, v108, v64
    v_fmac_f32 v110, v64, v96
    v_add_f32 v109, v109, v80
    v_fmac_f32 v111, v80, v96
    v_add_f32 v112, v112, v96
    v_add_f32 v108, v108, v65
    v_fmac_f32 v110, v65, v97
    v_add_f32 v109, v109, v81
    v_fmac_f32 v111, v81, v97
    v_add_f32 v112, v112, v97
    v_add_f32 v108, v108, v66
    v_fmac_f32 v110, v66, v98
    v_add_f32 v109, v109, v82
    v_fmac_f32 v111, v82, v98
    v_add_f32 v112, v112, v98
    v_add_f32 v108, v108, v67
    v_fmac_f32 v110, v67, v99
    v_add_f32 v109, v109, v83
    v_fmac_f32 v111, v83, v99
    v_add_f32 v112, v112, v99
    v_add_f32 v108, v108, v68
    v_fmac_f32 v110, v68, v100
    v_add_f32 v109, v109, v84
    v_fmac_f32 v111, v84, v100
    v_add_f32 v112, v112, v100
    v_add_f32 v108, v108, v69
    v_fmac_f32 v110, v69, v101
    v_add_f32 v109, v109, v85
    v_fmac_f32 v111, v85, v101
    v_add_f32 v112, v112, v101
    v_add_f32 v108, v108, v70
    v_fmac_f32 v110, v70, v102
    v_add_f32 v109, v109, v86
    v_fmac_f32 v111, v86, v102
    v_add_f32 v112, v112, v102
    v_add_f32 v108, v108, v71
    v_fmac_f32 v110, v71, v103
    v_add_f32 v109, v109, v87
    v_fmac_f32 v111, v87, v103
    v_add_f32 v112, v112, v103
    v_add_f32 v108, v108, v72
    v_fmac_f32 v110, v72, v104
    v_add_f32 v109, v109, v88
    v_fmac_f32 v111, v88, v104
    v_add_f32 v112, v112, v104
    s_barrier
    s_cmp_lg_u32 s55, 1
    s_cbranch_scc1 L_nocs16
    s_call_b64 s[52:53], L_colsum
L_nocs16:
    v_add_f32 v108, v108, v73
    v_fmac_f32 v110, v73, v105
    v_add_f32 v109, v109, v89
    v_fmac_f32 v111, v89, v105
    v_add_f32 v112, v112, v105
    v_add_f32 v108, v108, v74
    v_fmac_f32 v110, v74, v106
    v_add_f32 v109, v109, v90
    v_fmac_f32 v111, v90, v106
    v_add_f32 v112, v112, v106
    v_add_f32 v108, v108, v75
    v_fmac_f32 v110, v75, v107
    v_add_f32 v109, v109, v91
    v_fmac_f32 v111, v91, v107
    v_add_f32 v112, v112, v107
    v_add_f32_dpp v108, v108, v108 row_shr:1 row_mask:0xf bank_mask:0xf
    v_add_f32_dpp v109, v109, v109 row_shr:1 row_mask:0xf bank_mask:0xf
    v_add_f32_dpp v110, v110, v110 row_shr:1 row_mask:0xf bank_mask:0xf
    v_add_f32_dpp v111, v111, v111 row_shr:1 row_mask:0xf bank_mask:0xf
    v_add_f32_dpp v112, v112, v112 row_shr:1 row_mask:0xf bank_mask:0xf
    v_add_f32_dpp v108, v108, v108 row_shr:2 row_mask:0xf bank_mask:0xf
    v_add_f32_dpp v109, v109, v109 row_shr:2 row_mask:0xf bank_mask:0xf
    v_add_f32_dpp v110, v110, v110 row_shr:2 row_mask:0xf bank_mask:0xf
    v_add_f32_dpp v111, v111, v111 row_shr:2 row_mask:0xf bank_mask:0xf
    v_add_f32_dpp v112, v112, v112 row_shr:2 row_mask:0xf bank_mask:0xf
    v_add_f32_dpp v108, v108, v108 row_shr:4 row_mask:0xf bank_mask:0xf
    v_add_f32_dpp v109, v109, v109 row_shr:4 row_mask:0xf bank_mask:0xf
    v_add_f32_dpp v110, v110, v110 row_shr:4 row_mask:0xf bank_mask:0xf
    v_add_f32_dpp v111, v111, v111 row_shr:4 row_mask:0xf bank_mask:0xf
    v_add_f32_dpp v112, v112, v112 row_shr:4 row_mask:0xf bank_mask:0xf
    v_add_f32_dpp v108, v108, v108 row_shr:8 row_mask:0xf bank_mask:0xf
    v_add_f32_dpp v109, v109, v109 row_shr:8 row_mask:0xf bank_mask:0xf
    v_add_f32_dpp v110, v110, v110 row_shr:8 row_mask:0xf bank_mask:0xf
    v_add_f32_dpp v111, v111, v111 row_shr:8 row_mask:0xf bank_mask:0xf
    v_add_f32_dpp v112, v112, v112 row_shr:8 row_mask:0xf bank_mask:0xf
    v_add_f32_dpp v108, v108, v108 row_bcast:15 row_mask:0xa bank_mask:0xf
    v_add_f32_dpp v109, v109, v109 row_bcast:15 row_mask:0xa bank_mask:0xf
    v_add_f32_dpp v110, v110, v110 row_bcast:15 row_mask:0xa bank_mask:0xf
    v_add_f32_dpp v111, v111, v111 row_bcast:15 row_mask:0xa bank_mask:0xf
    v_add_f32_dpp v112, v112, v112 row_bcast:15 row_mask:0xa bank_mask:0xf
    v_add_f32_dpp v108, v108, v108 row_bcast:31 row_mask:0xc bank_mask:0xf
    v_add_f32_dpp v109, v109, v109 row_bcast:31 row_mask:0xc bank_mask:0xf
    v_add_f32_dpp v110, v110, v110 row_bcast:31 row_mask:0xc bank_mask:0xf
    v_add_f32_dpp v111, v111, v111 row_bcast:31 row_mask:0xc bank_mask:0xf
    v_add_f32_dpp v112, v112, v112 row_bcast:31 row_mask:0xc bank_mask:0xf
    v_readlane_b32 s70, v108, 63
    v_readlane_b32 s71, v109, 63
    v_readlane_b32 s72, v110, 63
    v_readlane_b32 s73, v111, 63
    v_readlane_b32 s74, v112, 63
    v_mov_b32 v114, s70
    v_mov_b32 v115, s71
    v_mul_f32 v114, 0x3a800000, v114
    v_mov_b32 v108, 0
    v_mul_f32 v115, 0x3a800000, v115
    v_mov_b32 v109, 0
    v_sub_f32 v116, v60, v114
    v_sub_f32 v117, v76, v115
    v_fmac_f32 v108, v116, v116
    v_fmac_f32 v109, v117, v117
    v_sub_f32 v116, v61, v114
    v_sub_f32 v117, v77, v115
    v_fmac_f32 v108, v116, v116
    v_fmac_f32 v109, v117, v117
    v_sub_f32 v116, v62, v114
    v_sub_f32 v117, v78, v115
    v_fmac_f32 v108, v116, v116
    v_fmac_f32 v109, v117, v117
    v_sub_f32 v116, v63, v114
    v_sub_f32 v117, v79, v115
    v_fmac_f32 v108, v116, v116
    v_fmac_f32 v109, v117, v117
    v_sub_f32 v116, v64, v114
    v_sub_f32 v117, v80, v115
    v_fmac_f32 v108, v116, v116
    v_fmac_f32 v109, v117, v117
    v_sub_f32 v116, v65, v114
    v_sub_f32 v117, v81, v115
    v_fmac_f32 v108, v116, v116
    v_fmac_f32 v109, v117, v117
    v_sub_f32 v116, v66, v114
    v_sub_f32 v117, v82, v115
    v_fmac_f32 v108, v116, v116
    v_fmac_f32 v109, v117, v117
    v_sub_f32 v116, v67, v114
    v_sub_f32 v117, v83, v115
    v_fmac_f32 v108, v116, v116
    v_fmac_f32 v109, v117, v117
    v_sub_f32 v116, v68, v114
    v_sub_f32 v117, v84, v115
    v_fmac_f32 v108, v116, v116
    v_fmac_f32 v109, v117, v117
    v_sub_f32 v116, v69, v114
    v_sub_f32 v117, v85, v115
    v_fmac_f32 v108, v116, v116
    v_fmac_f32 v109, v117, v117
    v_sub_f32 v116, v70, v114
    v_sub_f32 v117, v86, v115
    v_fmac_f32 v108, v116, v116
    v_fmac_f32 v109, v117, v117
    v_sub_f32 v116, v71, v114
    v_sub_f32 v117, v87, v115
    v_fmac_f32 v108, v116, v116
    v_fmac_f32 v109, v117, v117
    v_sub_f32 v116, v72, v114
    v_sub_f32 v117, v88, v115
    v_fmac_f32 v108, v116, v116
    v_fmac_f32 v109, v117, v117
    v_sub_f32 v116, v73, v114
    v_sub_f32 v117, v89, v115
    s_barrier
    s_cmp_lg_u32 s55, 2
    s_cbranch_scc1 L_nocs17
    s_call_b64 s[52:53], L_colsum
L_nocs17:
    v_fmac_f32 v108, v116, v116
    v_fmac_f32 v109, v117, v117
    v_sub_f32 v116, v74, v114
    v_sub_f32 v117, v90, v115
    v_fmac_f32 v108, v116, v116
    v_fmac_f32 v109, v117, v117
    v_sub_f32 v116, v75, v114
    v_sub_f32 v117, v91, v115
    v_fmac_f32 v108, v116, v116
    v_fmac_f32 v109, v117, v117
    s_nop 0
    v_add_f32_dpp v108, v108, v108 row_shr:1 row_mask:0xf bank_mask:0xf
    v_add_f32_dpp v109, v109, v109 row_shr:1 row_mask:0xf bank_mask:0xf
    s_nop 0
    v_add_f32_dpp v108, v108, v108 row_shr:2 row_mask:0xf bank_mask:0xf
    v_add_f32_dpp v109, v109, v109 row_shr:2 row_mask:0xf bank_mask:0xf
    s_nop 0
    v_add_f32_dpp v108, v108, v108 row_shr:4 row_mask:0xf bank_mask:0xf
    v_add_f32_dpp v109, v109, v109 row_shr:4 row_mask:0xf bank_mask:0xf
    s_nop 0
    v_add_f32_dpp v108, v108, v108 row_shr:8 row_mask:0xf bank_mask:0xf
    v_add_f32_dpp v109, v109, v109 row_shr:8 row_mask:0xf bank_mask:0xf
    s_nop 0
    v_add_f32_dpp v108, v108, v108 row_bcast:15 row_mask:0xa bank_mask:0xf
    v_add_f32_dpp v109, v109, v109 row_bcast:15 row_mask:0xa bank_mask:0xf
    s_nop 0
    v_add_f32_dpp v108, v108, v108 row_bcast:31 row_mask:0xc bank_mask:0xf
    v_add_f32_dpp v109, v109, v109 row_bcast:31 row_mask:0xc bank_mask:0xf
    s_nop 0
    v_readlane_b32 s70, v108, 63
    v_readlane_b32 s71, v109, 63
    v_cvt_pk_bf16_f32 v214, v114, v115
    v_lshlrev_b32 v114, 16, v214
    v_and_b32 v115, s64, v214
    v_mov_b32 v108, s70
    v_mov_b32 v109, s71
    v_mul_f32 v108, 0x3a800000, v108
    v_mul_f32 v109, 0x3a800000, v109
    v_cvt_pk_bf16_f32 v214, v108, v109
    v_lshlrev_b32 v108, 16, v214
    v_and_b32 v109, s64, v214
    v_add_f32 v108, 0x3727c5ac, v108
    v_add_f32 v109, 0x3727c5ac, v109
    v_cvt_pk_bf16_f32 v214, v108, v109
    v_lshlrev_b32 v108, 16, v214
    v_and_b32 v109, s64, v214
    v_sqrt_f32 v108, v108
    v_sqrt_f32 v109, v109
    s_nop 0
    v_cvt_pk_bf16_f32 v214, v108, v109
    v_lshlrev_b32 v108, 16, v214
    v_and_b32 v109, s64, v214
    v_rcp_f32 v110, v108
    v_rcp_f32 v111, v109
    v_lshrrev_b32 v120, 16, v114
    v_mov_b32 v116, s72
    v_lshrrev_b32 v122, 16, v115
    v_mov_b32 v117, s73
    v_or_b32 v120, v120, v108
    v_mov_b32 v121, s63
    v_or_b32 v122, v122, v109
    v_mov_b32 v123, s63
    v_fma_f32 v116, -v114, s74, v116
    v_fma_f32 v117, -v115, s74, v117
    v_mul_f32 v116, v116, v110
    v_mul_f32 v117, v117, v111
    v_cvt_pk_bf16_f32 v214, v116, v117
    v_mov_b32 v215, 0
    v_readfirstlane_b32 s70, v214
    s_nop 0
    s_lshr_b32 s71, s70, 16
    s_and_b32 s70, s70, 0xffff
    s_bitcmp1_b32 s70, 15
    s_cselect_b32 s73, 0x7fff, 0
    s_xor_b32 s70, s70, s73
    s_xor_b32 s70, s70, 0x8000
    s_lshl_b32 s70, s70, 16
    s_sub_u32 s73, 2047, s77
    s_or_b32 s70, s70, s73
    s_bitcmp1_b32 s71, 15
    s_cselect_b32 s73, 0x7fff, 0
    s_xor_b32 s71, s71, s73
    s_xor_b32 s71, s71, 0x8000
    s_lshl_b32 s71, s71, 16
    s_sub_u32 s73, 2046, s77
    s_or_b32 s71, s71, s73
    s_max_u32 s70, s70, s71
    v_mov_b32 v116, s70
    v_mov_b32 v117, s63
    s_lshl_b32 s70, s77, 3
    s_lshl_b32 s71, s77, 2
    s_add_u32 s71, s71, 0x4000
    s_mov_b64 exec, 1
    buffer_store_dwordx4 v[120:123], v215, s[32:35], s70 offen sc1
    buffer_store_dwordx2 v[116:117], v215, s[32:35], s71 offen sc1
    s_mov_b64 exec, -1
    v_lshrrev_b32 v244, 5, v1
    v_lshlrev_b32 v244, 9, v244
    v_bfe_u32 v247, v1, 2, 2
    v_lshl_add_u32 v244, v247, 7, v244
    v_and_b32 v247, 1, v1
    v_lshl_add_u32 v244, v247, 5, v244
    v_bfe_u32 v247, v1, 4, 1
    v_lshl_add_u32 v244, v247, 4, v244
    v_bfe_u32 v247, v1, 1, 1
    v_lshl_add_u32 v244, v247, 3, v244
    v_bfe_u32 v247, v1, 3, 1
    v_xor_b32 v247, s67, v247
    v_lshl_add_u32 v244, v247, 6, v244
    s_lshl_b32 s81, s67, 16
    v_add_u32 v244, s81, v244
    v_xor_b32 v245, 64, v244
    v_and_b32 v247, 31, v1
    v_lshlrev_b32 v247, 11, v247
    v_and_b32 v248, 32, v1
    v_add_u32 v246, v248, v247
    s_lshl_b32 s81, s68, 16
    s_lshl_b32 s82, s66, 7
    s_add_u32 s81, s81, s82
    s_lshl_b32 s82, s68, 16
    s_lshl_b32 s83, s67, 15
    s_add_u32 s82, s82, s83
    s_add_u32 s82, s82, 0xf00000
    s_and_b32 s83, s68, 62
    s_lshl_b32 s83, s83, 3
    s_add_u32 s83, s83, s66
    s_lshl_b32 s83, s83, 1
    s_add_u32 s83, s83, s67
    s_lshl_b32 s83, s83, 6
    s_add_u32 s83, s83, 0x2b0000
    v_lshlrev_b32 v208, 3, v1
    v_lshlrev_b32 v209, 2, v1
    v_cmp_gt_u32 vcc, 3, v1
    v_mov_b32 v215, 0x40000
    v_add_u32 v214, 129024, v209
    v_cndmask_b32 v215, -1, v215, vcc
    ds_write_b32 v214, v215
    v_mov_b32 v215, s63
    v_cmp_eq_u32 vcc, 9, v1
    v_mov_b32 v249, 129280
    s_nop 0
    v_cndmask_b32 v215, 0, v215, vcc
    ds_write_b32 v214, v215 offset:256
    s_mul_i32 s46, s75, 2341
    s_lshr_b32 s46, s46, 16
    s_mul_i32 s80, s46, 28
    s_sub_u32 s80, s75, s80
    s_barrier
    s_cmp_lg_u32 s55, 3
    s_cbranch_scc1 L_nocs18
    s_call_b64 s[52:53], L_colsum
L_nocs18:
    v_and_b32 v214, 15, v1
    v_lshrrev_b32 v216, 4, v1
    v_mul_u32_u24 v220, 28672, v216
    v_lshl_add_u32 v220, v214, 2, v220
    v_lshlrev_b32 v205, 4, v214
    v_lshl_add_u32 v217, v216, 13, v205
    v_lshl_add_u32 v241, v216, 12, v205
    v_mul_u32_u24 v216, 57344, v216
    v_add_u32 v216, v216, v205
    v_and_b32 v222, 16, v1
    v_lshl_add_u32 v222, v214, 5, v222
    v_lshlrev_b32 v223, 2, v1
    v_and_b32 v221, 124, v223
    v_and_b32 v240, 48, v1
    v_min_u32 v206, 55, v1
    v_lshlrev_b32 v206, 4, v206
    v_mov_b32 v207, 0
    v_bfe_u32 v214, v1, 4, 1
    v_lshlrev_b32 v214, 2, v214
    v_and_b32 v236, 7, v1
    v_xor_b32 v236, v236, v214
    v_lshrrev_b32 v214, 3, v1
    v_lshlrev_b32 v214, 11, v214
    v_lshl_add_u32 v236, v236, 4, v214
    v_add_u32 v237, 15360, v236
    v_add_u32 v238, 30720, v236
    v_add_u32 v239, 46080, v236
    s_lshl_b32 s77, s76, 13
    s_add_u32 s77, s77, 131072
    s_sub_u32 s73, s77, 65536
    v_add_u32 v242, s73, v244
    v_add_u32 v243, s73, v245
    v_add_u32 v204, s77, v2
    s_and_b32 s73, s76, 1
    s_lshl_b32 s73, s73, 18
    s_lshl_b32 s74, s61, 19
    s_add_u32 s73, s73, s74
    s_lshr_b32 s74, s76, 1
    s_lshl_b32 s74, s74, 13
    s_add_u32 s73, s73, s74
    s_lshl_b32 s74, s60, 14
    s_add_u32 s73, s73, s74
    s_add_u32 s44, s73, 0x700000
    s_add_u32 s45, s44, 4096
    s_lshl_b32 s73, s61, 11
    s_add_u32 s73, s73, 0x2a0000
    s_lshl_b32 s74, s60, 2
    s_add_u32 s47, s73, s74
    s_lshl_b32 s74, s60, 7
    s_add_u32 s73, s73, s74
    s_add_u32 s78, s20, s73
    s_addc_u32 s79, s21, 0
    v_lshlrev_b32 v252, 7, v1
    v_lshlrev_b32 v215, 1, v221
    s_lshl_b32 s48, s68, 8
    s_and_b32 s73, s76, 1
    s_lshl_b32 s74, s60, 10
    s_lshl_b32 s71, s73, 9
    s_add_u32 s74, s74, s71
    s_min_u32 s72, s76, 2
    s_lshl_b32 s75, s72, 13
    s_lshl_b32 s71, s61, 9
    s_add_u32 s75, s75, s71
    s_add_u32 s75, s75, 0x240000
    s_barrier
    s_cmp_lg_u32 s55, 4
    s_cbranch_scc1 L_nocs19
    s_call_b64 s[52:53], L_colsum
L_nocs19:
    s_barrier
    s_cmp_lg_u32 s55, 5
    s_cbranch_scc1 L_nocs20
    s_call_b64 s[52:53], L_colsum
L_nocs20:
    s_barrier
    s_cmp_lg_u32 s55, 6
    s_cbranch_scc1 L_nocs21
    s_call_b64 s[52:53], L_colsum
L_nocs21:
    s_barrier
    s_cmp_lg_u32 s55, 7
    s_cbranch_scc1 L_nocs22
    s_call_b64 s[52:53], L_colsum
L_nocs22:
    s_barrier
    s_barrier
    s_cmp_ge_u32 s76, 2
    s_cselect_b32 s74, 0x7f000000, s74
    s_cmp_eq_u32 s76, 3
    s_cselect_b32 s75, 0x7f000000, s75
    v_lshrrev_b32 v219, 5, v1
    v_mul_u32_u24 v219, 24576, v219
    v_lshl_add_u32 v219, v221, 2, v219
    v_and_b32 v174, 7, v1
    v_lshlrev_b32 v174, 5, v174
    v_and_b32 v214, 8, v1
    v_lshl_add_u32 v174, v214, 1, v174
    v_bfe_u32 v214, v1, 4, 1
    v_lshl_add_u32 v174, v214, 3, v174
    s_load_dwordx2 s[50:51], s[0:1], 72
    s_mov_b32 s84, 100000
    s_setprio 0
    buffer_load_dwordx2 v[36:37], v208, s[32:35], s74 offen sc1
    buffer_load_dwordx2 v[166:167], v215, s[32:35], s48 offen sc1
    s_mov_b32 s70, s75
    buffer_load_dwordx4 v[4:7], v219, s[32:35], s70 offen sc1
    s_add_u32 s70, s70, 49152
    buffer_load_dwordx4 v[8:11], v219, s[32:35], s70 offen sc1
    s_add_u32 s70, s70, 49152
    buffer_load_dwordx4 v[12:15], v219, s[32:35], s70 offen sc1
    s_add_u32 s70, s70, 49152
    buffer_load_dwordx4 v[16:19], v219, s[32:35], s70 offen sc1
    s_add_u32 s70, s70, 49152
    buffer_load_dwordx4 v[20:23], v219, s[32:35], s70 offen sc1
    s_add_u32 s70, s70, 49152
    buffer_load_dwordx4 v[24:27], v219, s[32:35], s70 offen sc1
    s_add_u32 s70, s70, 49152
    buffer_load_dwordx4 v[28:31], v219, s[32:35], s70 offen sc1
    s_add_u32 s70, s70, 49152
    buffer_load_dwordx4 v[32:35], v219, s[32:35], s70 offen sc1
    s_setprio 0
    s_barrier
    s_barrier
    s_barrier
L_tg7:
    s_waitcnt vmcnt(0)
    s_cmp_lt_u32 s76, 2
    s_cbranch_scc1 L_hasC10
    v_mov_b32 v37, s63
    s_cmp_lt_u32 s76, 3
    s_cbranch_scc1 L_hasC10
    v_mov_b32 v5, s63
    v_mov_b32 v7, s63
    v_mov_b32 v9, s63
    v_mov_b32 v11, s63
    v_mov_b32 v13, s63
    v_mov_b32 v15, s63
    v_mov_b32 v17, s63
    v_mov_b32 v19, s63
    v_mov_b32 v21, s63
    v_mov_b32 v23, s63
    v_mov_b32 v25, s63
    v_mov_b32 v27, s63
    v_mov_b32 v29, s63
    v_mov_b32 v31, s63
    v_mov_b32 v33, s63
    v_mov_b32 v35, s63
L_hasC10:
    v_xor_b32 v214, s63, v37
    v_bitop3_b32 v214, v214, v167, s63 bitop3:0xf6
    v_bitop3_b32 v214, v214, v5, s63 bitop3:0xf6
    v_bitop3_b32 v214, v214, v7, s63 bitop3:0xf6
    v_bitop3_b32 v214, v214, v9, s63 bitop3:0xf6
    v_bitop3_b32 v214, v214, v11, s63 bitop3:0xf6
    v_bitop3_b32 v214, v214, v13, s63 bitop3:0xf6
    v_bitop3_b32 v214, v214, v15, s63 bitop3:0xf6
    v_bitop3_b32 v214, v214, v17, s63 bitop3:0xf6
    v_bitop3_b32 v214, v214, v19, s63 bitop3:0xf6
    v_bitop3_b32 v214, v214, v21, s63 bitop3:0xf6
    v_bitop3_b32 v214, v214, v23, s63 bitop3:0xf6
    v_bitop3_b32 v214, v214, v25, s63 bitop3:0xf6
    v_bitop3_b32 v214, v214, v27, s63 bitop3:0xf6
    v_bitop3_b32 v214, v214, v29, s63 bitop3:0xf6
    v_bitop3_b32 v214, v214, v31, s63 bitop3:0xf6
    v_bitop3_b32 v214, v214, v33, s63 bitop3:0xf6
    v_bitop3_b32 v214, v214, v35, s63 bitop3:0xf6
    v_cmp_ne_u32 vcc, 0, v214
    s_cbranch_vccz L_tgdone8
    s_sub_u32 s84, s84, 1
    s_cbranch_scc1 L_tgdone8
    s_sleep 4
    s_setprio 0
    buffer_load_dwordx2 v[36:37], v208, s[32:35], s74 offen sc1
    buffer_load_dwordx2 v[166:167], v215, s[32:35], s48 offen sc1
    s_mov_b32 s70, s75
    buffer_load_dwordx4 v[4:7], v219, s[32:35], s70 offen sc1
    s_add_u32 s70, s70, 49152
    buffer_load_dwordx4 v[8:11], v219, s[32:35], s70 offen sc1
    s_add_u32 s70, s70, 49152
    buffer_load_dwordx4 v[12:15], v219, s[32:35], s70 offen sc1
    s_add_u32 s70, s70, 49152
    buffer_load_dwordx4 v[16:19], v219, s[32:35], s70 offen sc1
    s_add_u32 s70, s70, 49152
    buffer_load_dwordx4 v[20:23], v219, s[32:35], s70 offen sc1
    s_add_u32 s70, s70, 49152
    buffer_load_dwordx4 v[24:27], v219, s[32:35], s70 offen sc1
    s_add_u32 s70, s70, 49152
    buffer_load_dwordx4 v[28:31], v219, s[32:35], s70 offen sc1
    s_add_u32 s70, s70, 49152
    buffer_load_dwordx4 v[32:35], v219, s[32:35], s70 offen sc1
    s_setprio 0
    s_branch L_tg7
L_tgdone8:
    s_cmp_ge_u32 s76, 2
    s_cbranch_scc1 L_nowr11
    s_lshl_b32 s70, s73, 8
    s_add_u32 s70, s70, 126976
    v_add_u32 v208, s70, v209
    v_and_b32 v37, s64, v36
    v_rcp_f32 v37, v37
    v_lshlrev_b32 v36, 16, v36
    ds_write_b32 v208, v36
    ds_write_b32 v208, v37 offset:512
L_nowr11:
    s_cmp_eq_u32 s76, 3
    s_cbranch_scc1 L_nowr12
    v_add_f32 v4, v4, v8
    v_add_f32 v6, v6, v10
    v_add_f32 v4, v4, v12
    v_add_f32 v6, v6, v14
    v_add_f32 v4, v4, v16
    v_add_f32 v6, v6, v18
    v_add_f32 v4, v4, v20
    v_add_f32 v6, v6, v22
    v_add_f32 v4, v4, v24
    v_add_f32 v6, v6, v26
    v_add_f32 v4, v4, v28
    v_add_f32 v6, v6, v30
    v_add_f32 v4, v4, v32
    v_add_f32 v6, v6, v34
    v_mov_b32 v5, v6
    v_mov_b32 v8, v4
    v_mov_b32 v9, v6
    s_lshl_b32 s70, s72, 8
    s_add_u32 s70, s70, 128000
    v_permlane32_swap_b32 v8, v4
    v_permlane32_swap_b32 v9, v5
    v_add_u32 v208, s70, v174
    v_add_f32 v4, v4, v8
    v_add_f32 v5, v5, v9
    ds_write_b64 v208, v[4:5]
L_nowr12:
    s_waitcnt lgkmcnt(0)
    s_barrier
    v_and_b32 v167, s64, v166
    v_rcp_f32 v167, v167
    v_lshlrev_b32 v166, 16, v166
    v_mul_f32 v166, v166, v167
    v_add_f32 v167, 1.0, v167
    s_barrier
    s_barrier
    s_waitcnt lgkmcnt(0)
    s_movk_i32 s70, 0x4000
    s_movk_i32 s71, 0x5000
    s_cmp_lg_u32 s76, 3
    s_cbranch_scc1 L_nokeys13
    s_setprio 1
    buffer_load_dwordx4 v[40:43], v2, s[32:35], s70 offen offset:0 sc1
    buffer_load_dwordx4 v[44:47], v2, s[32:35], s70 offen offset:1024 sc1
    buffer_load_dwordx4 v[48:51], v2, s[32:35], s70 offen offset:2048 sc1
    buffer_load_dwordx4 v[52:55], v2, s[32:35], s70 offen offset:3072 sc1
    buffer_load_dwordx4 v[56:59], v2, s[32:35], s71 offen offset:0 sc1
    buffer_load_dwordx4 v[60:63], v2, s[32:35], s71 offen offset:1024 sc1
    buffer_load_dwordx4 v[64:67], v2, s[32:35], s71 offen offset:2048 sc1
    buffer_load_dwordx4 v[68:71], v2, s[32:35], s71 offen offset:3072 sc1
    s_setprio 0
L_nokeys13:
    s_mov_b32 s56, s50
    s_and_b32 s57, s51, 0xffff
    s_mov_b32 s58, 0x100
    s_mov_b32 s59, 0x00020000
    s_cmp_lg_u32 s76, 0
    s_cbranch_scc1 L_norank14
    v_mov_b32 v40, 1
    s_lshl_b32 s72, s61, 4
    s_mov_b64 exec, 1
    buffer_atomic_add v40, v207, s[56:59], s72 offen sc0 sc1
    s_mov_b64 exec, -1
L_norank14:
    s_cmp_lg_u32 s76, 3
    s_cbranch_scc1 L_nokeys23
    s_mov_b32 s84, 100000
L_tg25:
    s_waitcnt vmcnt(0)
    v_xor_b32 v214, s63, v41
    v_bitop3_b32 v214, v214, v43, s63 bitop3:0xf6
    v_bitop3_b32 v214, v214, v45, s63 bitop3:0xf6
    v_bitop3_b32 v214, v214, v47, s63 bitop3:0xf6
    v_bitop3_b32 v214, v214, v49, s63 bitop3:0xf6
    v_bitop3_b32 v214, v214, v51, s63 bitop3:0xf6
    v_bitop3_b32 v214, v214, v53, s63 bitop3:0xf6
    v_bitop3_b32 v214, v214, v55, s63 bitop3:0xf6
    v_bitop3_b32 v214, v214, v57, s63 bitop3:0xf6
    v_bitop3_b32 v214, v214, v59, s63 bitop3:0xf6
    v_bitop3_b32 v214, v214, v61, s63 bitop3:0xf6
    v_bitop3_b32 v214, v214, v63, s63 bitop3:0xf6
    v_bitop3_b32 v214, v214, v65, s63 bitop3:0xf6
    v_bitop3_b32 v214, v214, v67, s63 bitop3:0xf6
    v_bitop3_b32 v214, v214, v69, s63 bitop3:0xf6
    v_bitop3_b32 v214, v214, v71, s63 bitop3:0xf6
    v_cmp_ne_u32 vcc, 0, v214
    s_cbranch_vccz L_tgdone26
    s_sub_u32 s84, s84, 1
    s_cbranch_scc1 L_tgdone26
    s_sleep 4
    buffer_load_dwordx4 v[40:43], v2, s[32:35], s70 offen offset:0 sc1
    buffer_load_dwordx4 v[44:47], v2, s[32:35], s70 offen offset:1024 sc1
    buffer_load_dwordx4 v[48:51], v2, s[32:35], s70 offen offset:2048 sc1
    buffer_load_dwordx4 v[52:55], v2, s[32:35], s70 offen offset:3072 sc1
    buffer_load_dwordx4 v[56:59], v2, s[32:35], s71 offen offset:0 sc1
    buffer_load_dwordx4 v[60:63], v2, s[32:35], s71 offen offset:1024 sc1
    buffer_load_dwordx4 v[64:67], v2, s[32:35], s71 offen offset:2048 sc1
    buffer_load_dwordx4 v[68:71], v2, s[32:35], s71 offen offset:3072 sc1
    s_branch L_tg25
L_tgdone26:
    v_max_u32 v40, v40, v42
    v_max3_u32 v40, v40, v44, v46
    v_max3_u32 v40, v40, v48, v50
    v_max3_u32 v40, v40, v52, v54
    v_max3_u32 v40, v40, v56, v58
    v_max3_u32 v40, v40, v60, v62
    v_max3_u32 v40, v40, v64, v66
    v_max3_u32 v40, v40, v68, v70
    s_nop 1
    v_max_u32_dpp v40, v40, v40 row_shr:1 row_mask:0xf bank_mask:0xf
    s_nop 1
    v_max_u32_dpp v40, v40, v40 row_shr:2 row_mask:0xf bank_mask:0xf
    s_nop 1
    v_max_u32_dpp v40, v40, v40 row_shr:4 row_mask:0xf bank_mask:0xf
    s_nop 1
    v_max_u32_dpp v40, v40, v40 row_shr:8 row_mask:0xf bank_mask:0xf
    s_nop 1
    v_max_u32_dpp v40, v40, v40 row_bcast:15 row_mask:0xa bank_mask:0xf
    s_nop 1
    v_max_u32_dpp v40, v40, v40 row_bcast:31 row_mask:0xc bank_mask:0xf
    v_mov_b32 v214, 130560
    s_mov_b32 exec_lo, 0
    s_mov_b32 exec_hi, 0x80000000
    ds_write_b32 v214, v40
    s_mov_b64 exec, -1
    s_cmp_lg_u32 s2, 0
    s_cbranch_scc1 L_nokeys23
    s_add_u32 s70, s22, 1
    s_movk_i32 s71, 0x6000
    v_mov_b32 v218, s70
    v_mov_b32 v219, 0
    s_waitcnt vmcnt(0)
    s_mov_b64 exec, 1
    buffer_store_dword v218, v219, s[32:35], s71 offen sc1
    s_mov_b64 exec, -1
L_nokeys23:
    s_cmp_lg_u32 s76, 0
    s_cbranch_scc1 L_norank24
    v_mov_b32 v214, 130564
    s_waitcnt vmcnt(0)
    s_mov_b64 exec, 1
    ds_write_b32 v214, v40
    s_mov_b64 exec, -1
L_norank24:
    s_lshl_b32 s48, 1, s60
    s_mov_b32 s23, 129092
    s_mov_b32 s22, 100000
    s_cmp_eq_u32 s76, 0
    s_cselect_b32 s23, s23, 0
    v_mov_b32 v214, 130560
    s_mov_b32 s28, s14
    s_and_b32 s29, s15, 0xffff
    s_mov_b32 s30, 0x700000
    s_mov_b32 s31, 0x00020000
    s_mov_b32 s56, s16
    s_and_b32 s57, s17, 0xffff
    s_mov_b32 s58, 0x700000
    s_mov_b32 s59, 0x00020000
    s_setprio 1
    s_waitcnt lgkmcnt(0)
    s_barrier
    ds_read_b64 v[164:165], v214
    ds_read_b128 v[132:135], v204 offset:0
    ds_read_b128 v[136:139], v204 offset:1024
    ds_read_b128 v[140:143], v204 offset:2048
    ds_read_b128 v[144:147], v204 offset:3072
    ds_read_b128 v[148:151], v204 offset:4096
    ds_read_b128 v[152:155], v204 offset:5120
    ds_read_b128 v[156:159], v204 offset:6144
    ds_read_b128 v[160:163], v204 offset:7168
    s_waitcnt lgkmcnt(0)
    v_readfirstlane_b32 s69, v164
    v_readfirstlane_b32 s51, v165
    s_nop 0
    s_and_b32 s51, s51, 15
    s_sub_u32 s51, s51, 6
    s_cbranch_scc0 L_late30
    buffer_store_dwordx4 v[132:135], v2, s[32:35], s44 offen offset:0 sc1
    buffer_store_dwordx4 v[136:139], v2, s[32:35], s44 offen offset:1024 sc1
    buffer_store_dwordx4 v[140:143], v2, s[32:35], s44 offen offset:2048 sc1
    buffer_store_dwordx4 v[144:147], v2, s[32:35], s44 offen offset:3072 sc1
    buffer_store_dwordx4 v[148:151], v2, s[32:35], s45 offen offset:0 sc1
    buffer_store_dwordx4 v[152:155], v2, s[32:35], s45 offen offset:1024 sc1
    buffer_store_dwordx4 v[156:159], v2, s[32:35], s45 offen offset:2048 sc1
    buffer_store_dwordx4 v[160:163], v2, s[32:35], s45 offen offset:3072 sc1
L_late30:
    s_and_b32 s70, s69, 0x7ff
    s_sub_u32 s70, 2047, s70
    s_lshl_b32 s72, s70, 3
    s_lshl_b32 s70, s70, 11
    s_min_u32 s71, s46, 31
    s_lshl_b32 s71, s71, 6
    s_add_u32 s70, s70, s71
    buffer_load_dwordx4 v[184:187], v240, s[24:27], s70 offen
    buffer_load_dwordx2 v[164:165], v207, s[32:35], s72 offen sc1
    s_cmp_lt_i32 s51, 0
    s_cbranch_scc0 L_both31
    s_waitcnt vmcnt(2)
    s_call_b64 s[52:53], L_arrive
L_both31:
    s_cmp_eq_u32 s23, 0
    s_cbranch_scc1 L_tk32
    s_load_dwordx16 s[4:19], s[78:79], 0 glc
L_tk32:
    s_cmp_le_u32 s23, 129088
    s_cbranch_scc1 L_tk33
    s_call_b64 s[54:55], L_list
L_tk33:
    s_barrier
L_fill34:
    s_cmp_le_u32 s23, 129088
    s_cbranch_scc1 L_filled35
    s_call_b64 s[54:55], L_list
    s_branch L_fill34
L_filled35:
    s_waitcnt lgkmcnt(0)
    s_barrier
    s_cmp_ge_i32 s51, 0
    s_cselect_b32 s85, 1, 0
    s_add_u32 s51, s51, s85
    s_setprio 0
    s_cmp_ge_u32 s3, 224
    s_cbranch_scc1 L_nojob38
    s_mov_b32 s84, 100000
L_tg39:
    s_waitcnt vmcnt(0)
    v_xor_b32 v214, s63, v165
    v_cmp_ne_u32 vcc, 0, v214
    s_cbranch_vccz L_tgdone40
    s_sub_u32 s84, s84, 1
    s_cbranch_scc1 L_tgdone40
    s_sleep 16
    buffer_load_dwordx2 v[164:165], v207, s[32:35], s72 offen sc1
    s_branch L_tg39
L_tgdone40:
    s_mul_i32 s74, s46, 229376
    s_lshl_b32 s71, s80, 8
    s_add_u32 s74, s74, s71
    s_lshl_b32 s75, s3, 15
    s_lshl_b32 s71, s76, 9
    s_add_u32 s75, s75, s71
    s_cmp_lg_u32 s51, 0
    s_cbranch_scc1 L_tk41
    s_call_b64 s[52:53], L_publish
L_tk41:
    s_cmp_le_u32 s23, 129032
    s_cbranch_scc1 L_tk42
    s_call_b64 s[54:55], L_list
L_tk42:
    buffer_load_dwordx4 v[4:7], v216, s[28:31], s74 offen nt
    v_and_b32 v165, s64, v164
    v_rcp_f32 v165, v165
    v_lshlrev_b32 v164, 16, v164
    v_and_b32 v193, s64, v184
    v_lshlrev_b32 v192, 16, v184
    s_waitcnt vmcnt(2)
    s_cmp_lg_u32 s51, 1
    s_cbranch_scc1 L_tk43
    s_call_b64 s[52:53], L_publish
L_tk43:
    s_cmp_le_u32 s23, 129032
    s_cbranch_scc1 L_tk44
    s_call_b64 s[54:55], L_list
L_tk44:
    buffer_load_dwordx4 v[8:11], v216, s[56:59], s74 offen nt
    s_add_u32 s74, s74, 7168
    v_and_b32 v195, s64, v185
    v_lshlrev_b32 v194, 16, v185
    v_and_b32 v197, s64, v186
    v_lshlrev_b32 v196, 16, v186
    v_and_b32 v199, s64, v187
    s_waitcnt vmcnt(2)
    s_cmp_lg_u32 s51, 2
    s_cbranch_scc1 L_tk45
    s_call_b64 s[52:53], L_publish
L_tk45:
    s_cmp_le_u32 s23, 129032
    s_cbranch_scc1 L_tk46
    s_call_b64 s[54:55], L_list
L_tk46:
    buffer_load_dwordx4 v[12:15], v216, s[28:31], s74 offen nt
    v_lshlrev_b32 v198, 16, v187
    v_subrev_f32 v192, v164, v192
    v_subrev_f32 v193, v164, v193
    v_subrev_f32 v194, v164, v194
    v_subrev_f32 v195, v164, v195
    s_waitcnt vmcnt(2)
    s_cmp_lg_u32 s51, 3
    s_cbranch_scc1 L_tk47
    s_call_b64 s[52:53], L_publish
L_tk47:
    s_cmp_le_u32 s23, 129032
    s_cbranch_scc1 L_tk48
    s_call_b64 s[54:55], L_list
L_tk48:
    buffer_load_dwordx4 v[16:19], v216, s[56:59], s74 offen nt
    s_add_u32 s74, s74, 7168
    v_subrev_f32 v196, v164, v196
    v_subrev_f32 v197, v164, v197
    v_subrev_f32 v198, v164, v198
    v_subrev_f32 v199, v164, v199
    v_cvt_pk_bf16_f32 v214, v192, v193
    s_waitcnt vmcnt(2)
    s_cmp_lg_u32 s51, 4
    s_cbranch_scc1 L_tk49
    s_call_b64 s[52:53], L_publish
L_tk49:
    s_cmp_le_u32 s23, 129032
    s_cbranch_scc1 L_tk50
    s_call_b64 s[54:55], L_list
L_tk50:
    buffer_load_dwordx4 v[20:23], v216, s[28:31], s74 offen nt
    v_lshlrev_b32 v192, 16, v214
    v_and_b32 v193, s64, v214
    v_cvt_pk_bf16_f32 v214, v194, v195
    v_lshlrev_b32 v194, 16, v214
    v_and_b32 v195, s64, v214
    s_waitcnt vmcnt(2)
    s_cmp_lg_u32 s51, 5
    s_cbranch_scc1 L_tk51
    s_call_b64 s[52:53], L_publish
L_tk51:
    s_cmp_le_u32 s23, 129032
    s_cbranch_scc1 L_tk52
    s_call_b64 s[54:55], L_list
L_tk52:
    buffer_load_dwordx4 v[24:27], v216, s[56:59], s74 offen nt
    s_add_u32 s74, s74, 7168
    v_cvt_pk_bf16_f32 v214, v196, v197
    v_lshlrev_b32 v196, 16, v214
    v_and_b32 v197, s64, v214
    v_cvt_pk_bf16_f32 v214, v198, v199
    v_lshlrev_b32 v198, 16, v214
    s_waitcnt vmcnt(2)
    s_cmp_lg_u32 s51, 6
    s_cbranch_scc1 L_tk53
    s_call_b64 s[52:53], L_publish
L_tk53:
    s_cmp_le_u32 s23, 129032
    s_cbranch_scc1 L_tk54
    s_call_b64 s[54:55], L_list
L_tk54:
    buffer_load_dwordx4 v[28:31], v216, s[28:31], s74 offen nt
    v_and_b32 v199, s64, v214
    v_mul_f32 v192, v165, v192
    v_mul_f32 v193, v165, v193
    v_mul_f32 v194, v165, v194
    v_mul_f32 v195, v165, v195
    s_waitcnt vmcnt(2)
    s_cmp_lg_u32 s51, 7
    s_cbranch_scc1 L_tk55
    s_call_b64 s[52:53], L_publish
L_tk55:
    s_cmp_le_u32 s23, 129032
    s_cbranch_scc1 L_tk56
    s_call_b64 s[54:55], L_list
L_tk56:
    buffer_load_dwordx4 v[32:35], v216, s[56:59], s74 offen nt
    s_add_u32 s74, s74, 7168
    v_mul_f32 v196, v165, v196
    v_mul_f32 v197, v165, v197
    v_mul_f32 v198, v165, v198
    v_mul_f32 v199, v165, v199
    v_cvt_pk_bf16_f32 v214, v192, v192
    s_waitcnt vmcnt(2)
    s_cmp_lg_u32 s51, 8
    s_cbranch_scc1 L_tk57
    s_call_b64 s[52:53], L_publish
L_tk57:
    s_cmp_le_u32 s23, 129032
    s_cbranch_scc1 L_tk58
    s_call_b64 s[54:55], L_list
L_tk58:
    buffer_load_dwordx4 v[36:39], v216, s[28:31], s74 offen nt
    v_and_b32 v100, v214, v210
    v_and_b32 v101, v214, v211
    v_and_b32 v102, v214, v212
    v_and_b32 v103, v214, v213
    v_cvt_pk_bf16_f32 v214, v193, v193
    s_waitcnt vmcnt(2)
    s_cmp_lg_u32 s51, 9
    s_cbranch_scc1 L_tk59
    s_call_b64 s[52:53], L_publish
L_tk59:
    s_cmp_le_u32 s23, 129032
    s_cbranch_scc1 L_tk60
    s_call_b64 s[54:55], L_list
L_tk60:
    buffer_load_dwordx4 v[40:43], v216, s[56:59], s74 offen nt
    s_add_u32 s74, s74, 7168
    v_and_b32 v104, v214, v210
    v_and_b32 v105, v214, v211
    v_and_b32 v106, v214, v212
    v_and_b32 v107, v214, v213
    v_cvt_pk_bf16_f32 v214, v194, v194
    s_waitcnt vmcnt(2)
    s_cmp_lg_u32 s51, 10
    s_cbranch_scc1 L_tk61
    s_call_b64 s[52:53], L_publish
L_tk61:
    s_cmp_le_u32 s23, 129032
    s_cbranch_scc1 L_tk62
    s_call_b64 s[54:55], L_list
L_tk62:
    buffer_load_dwordx4 v[44:47], v216, s[28:31], s74 offen nt
    v_and_b32 v108, v214, v210
    v_and_b32 v109, v214, v211
    v_and_b32 v110, v214, v212
    v_and_b32 v111, v214, v213
    v_cvt_pk_bf16_f32 v214, v195, v195
    s_waitcnt vmcnt(2)
    s_cmp_le_u32 s23, 129032
    s_cbranch_scc1 L_tk63
    s_call_b64 s[54:55], L_list
L_tk63:
    buffer_load_dwordx4 v[48:51], v216, s[56:59], s74 offen nt
    s_add_u32 s74, s74, 7168
    v_and_b32 v112, v214, v210
    v_and_b32 v113, v214, v211
    v_and_b32 v114, v214, v212
    v_and_b32 v115, v214, v213
    v_cvt_pk_bf16_f32 v214, v196, v196
    s_waitcnt vmcnt(2)
    s_cmp_le_u32 s23, 129032
    s_cbranch_scc1 L_tk64
    s_call_b64 s[54:55], L_list
L_tk64:
    buffer_load_dwordx4 v[52:55], v216, s[28:31], s74 offen nt
    v_and_b32 v116, v214, v210
    v_and_b32 v117, v214, v211
    v_and_b32 v118, v214, v212
    v_and_b32 v119, v214, v213
    v_cvt_pk_bf16_f32 v214, v197, v197
    s_waitcnt vmcnt(2)
    s_cmp_le_u32 s23, 129032
    s_cbranch_scc1 L_tk65
    s_call_b64 s[54:55], L_list
L_tk65:
    buffer_load_dwordx4 v[56:59], v216, s[56:59], s74 offen nt
    s_add_u32 s74, s74, 7168
    v_and_b32 v120, v214, v210
    v_and_b32 v121, v214, v211
    v_and_b32 v122, v214, v212
    v_and_b32 v123, v214, v213
    v_cvt_pk_bf16_f32 v214, v198, v198
    s_waitcnt vmcnt(2)
    s_cmp_le_u32 s23, 129032
    s_cbranch_scc1 L_tk66
    s_call_b64 s[54:55], L_list
L_tk66:
    buffer_load_dwordx4 v[60:63], v216, s[28:31], s74 offen nt
    v_and_b32 v124, v214, v210
    v_and_b32 v125, v214, v211
    v_and_b32 v126, v214, v212
    v_and_b32 v127, v214, v213
    v_cvt_pk_bf16_f32 v214, v199, v199
    s_waitcnt vmcnt(2)
    s_cmp_le_u32 s23, 129032
    s_cbranch_scc1 L_tk67
    s_call_b64 s[54:55], L_list
L_tk67:
    buffer_load_dwordx4 v[64:67], v216, s[56:59], s74 offen nt
    s_add_u32 s74, s74, 7168
    v_and_b32 v128, v214, v210
    v_and_b32 v129, v214, v211
    v_and_b32 v130, v214, v212
    v_and_b32 v131, v214, v213
    s_waitcnt vmcnt(2)
    buffer_load_dwordx4 v[168:171], v246, s[24:27], s81 offen offset:0
    buffer_load_dwordx4 v[172:175], v246, s[24:27], s81 offen offset:16
    buffer_load_dwordx4 v[176:179], v246, s[24:27], s81 offen offset:64
    buffer_load_dwordx4 v[180:183], v246, s[24:27], s81 offen offset:80
    s_waitcnt lgkmcnt(0)
    s_load_dwordx2 s[28:29], s[0:1], 56
    s_waitcnt vmcnt(0) lgkmcnt(0)
    s_mov_b32 s28, s28
    s_and_b32 s29, s29, 0xffff
    s_mov_b32 s30, 0x700000
    s_mov_b32 s31, 0x00020000
    v_mfma_f32_16x16x32_bf16 v[224:227], v[100:103], v[4:7], 0
    v_mfma_f32_16x16x32_bf16 v[228:231], v[100:103], v[8:11], 0
    v_mfma_f32_16x16x32_bf16 v[224:227], v[104:107], v[12:15], v[224:227]
    v_mfma_f32_16x16x32_bf16 v[228:231], v[104:107], v[16:19], v[228:231]
    v_mfma_f32_16x16x32_bf16 v[224:227], v[108:111], v[20:23], v[224:227]
    v_mfma_f32_16x16x32_bf16 v[228:231], v[108:111], v[24:27], v[228:231]
    v_mfma_f32_16x16x32_bf16 v[224:227], v[112:115], v[28:31], v[224:227]
    v_mfma_f32_16x16x32_bf16 v[228:231], v[112:115], v[32:35], v[228:231]
    v_mfma_f32_16x16x32_bf16 v[224:227], v[116:119], v[36:39], v[224:227]
    v_mfma_f32_16x16x32_bf16 v[228:231], v[116:119], v[40:43], v[228:231]
    v_mfma_f32_16x16x32_bf16 v[224:227], v[120:123], v[44:47], v[224:227]
    v_mfma_f32_16x16x32_bf16 v[228:231], v[120:123], v[48:51], v[228:231]
    v_mfma_f32_16x16x32_bf16 v[224:227], v[124:127], v[52:55], v[224:227]
    v_mfma_f32_16x16x32_bf16 v[228:231], v[124:127], v[56:59], v[228:231]
    v_mfma_f32_16x16x32_bf16 v[224:227], v[128:131], v[60:63], v[224:227]
    v_mfma_f32_16x16x32_bf16 v[228:231], v[128:131], v[64:67], v[228:231]
    s_mul_i32 s70, s46, 28672
    s_lshl_b32 s71, s80, 9
    s_add_u32 s70, s70, s71
    s_add_u32 s70, s70, 0x40000
    s_add_u32 s71, s70, 14336
    s_lshl_b32 s72, s80, 5
    s_add_u32 s72, s72, s46
    s_lshl_b32 s72, s72, 2
    s_add_u32 s72, s72, 0x234000
    s_mov_b64 exec, 0xffffffff
    buffer_store_dwordx4 v[224:227], v222, s[32:35], s70 offen sc1
    buffer_store_dwordx4 v[228:231], v222, s[32:35], s71 offen sc1
    s_mov_b64 exec, -1
    v_mov_b32 v218, s63
    v_mov_b32 v219, 0
    s_waitcnt vmcnt(0)
    s_mov_b64 exec, 1
    buffer_store_dword v218, v219, s[32:35], s72 offen sc1
    s_mov_b64 exec, -1
    buffer_load_dwordx4 v[68:71], v217, s[28:31], s75 offen offset:0 nt
    s_cmp_le_u32 s23, 129032
    s_cbranch_scc1 L_tk68
    s_call_b64 s[54:55], L_list
L_tk68:
    s_waitcnt vmcnt(3)
    buffer_load_dwordx4 v[72:75], v217, s[28:31], s75 offen offset:256 nt
    s_cmp_le_u32 s23, 129032
    s_cbranch_scc1 L_tk69
    s_call_b64 s[54:55], L_list
L_tk69:
    s_waitcnt vmcnt(3)
    buffer_load_dwordx4 v[76:79], v217, s[28:31], s75 offen offset:2048 nt
    s_cmp_le_u32 s23, 129032
    s_cbranch_scc1 L_tk70
    s_call_b64 s[54:55], L_list
L_tk70:
    s_waitcnt vmcnt(3)
    buffer_load_dwordx4 v[80:83], v217, s[28:31], s75 offen offset:2304 nt
    s_add_u32 s75, s75, 4096
    s_cmp_le_u32 s23, 129032
    s_cbranch_scc1 L_tk71
    s_call_b64 s[54:55], L_list
L_tk71:
    s_waitcnt vmcnt(3)
    buffer_load_dwordx4 v[84:87], v217, s[28:31], s75 offen offset:0 nt
    s_cmp_le_u32 s23, 129032
    s_cbranch_scc1 L_tk72
    s_call_b64 s[54:55], L_list
L_tk72:
    s_waitcnt vmcnt(3)
    buffer_load_dwordx4 v[88:91], v217, s[28:31], s75 offen offset:256 nt
    s_cmp_le_u32 s23, 129032
    s_cbranch_scc1 L_tk73
    s_call_b64 s[54:55], L_list
L_tk73:
    s_waitcnt vmcnt(3)
    buffer_load_dwordx4 v[92:95], v217, s[28:31], s75 offen offset:2048 nt
    s_cmp_le_u32 s23, 129032
    s_cbranch_scc1 L_tk74
    s_call_b64 s[54:55], L_list
L_tk74:
    s_waitcnt vmcnt(3)
    buffer_load_dwordx4 v[96:99], v217, s[28:31], s75 offen offset:2304 nt
    s_cmp_le_u32 s23, 129032
    s_cbranch_scc1 L_tk75
    s_call_b64 s[54:55], L_list
L_tk75:
    s_waitcnt vmcnt(3)
    s_branch L_nom137
L_nojob38:
    buffer_load_dwordx4 v[168:171], v246, s[24:27], s81 offen offset:0
    buffer_load_dwordx4 v[172:175], v246, s[24:27], s81 offen offset:16
    buffer_load_dwordx4 v[176:179], v246, s[24:27], s81 offen offset:64
    buffer_load_dwordx4 v[180:183], v246, s[24:27], s81 offen offset:80
    s_cmp_lg_u32 s51, 0
    s_cbranch_scc1 L_tk76
    s_call_b64 s[52:53], L_publish
L_tk76:
    s_cmp_le_u32 s23, 129032
    s_cbranch_scc1 L_tk77
    s_call_b64 s[54:55], L_list
L_tk77:
    s_waitcnt vmcnt(0)
    s_sleep 10
    s_cmp_lg_u32 s51, 1
    s_cbranch_scc1 L_tk78
    s_call_b64 s[52:53], L_publish
L_tk78:
    s_cmp_le_u32 s23, 129032
    s_cbranch_scc1 L_tk79
    s_call_b64 s[54:55], L_list
L_tk79:
    s_waitcnt vmcnt(0)
    s_sleep 10
    s_cmp_lg_u32 s51, 2
    s_cbranch_scc1 L_tk80
    s_call_b64 s[52:53], L_publish
L_tk80:
    s_cmp_le_u32 s23, 129032
    s_cbranch_scc1 L_tk81
    s_call_b64 s[54:55], L_list
L_tk81:
    s_waitcnt vmcnt(0)
    s_sleep 10
    s_cmp_lg_u32 s51, 3
    s_cbranch_scc1 L_tk82
    s_call_b64 s[52:53], L_publish
L_tk82:
    s_cmp_le_u32 s23, 129032
    s_cbranch_scc1 L_tk83
    s_call_b64 s[54:55], L_list
L_tk83:
    s_waitcnt vmcnt(0)
    s_sleep 10
    s_cmp_lg_u32 s51, 4
    s_cbranch_scc1 L_tk84
    s_call_b64 s[52:53], L_publish
L_tk84:
    s_cmp_le_u32 s23, 129032
    s_cbranch_scc1 L_tk85
    s_call_b64 s[54:55], L_list
L_tk85:
    s_waitcnt vmcnt(0)
    s_sleep 10
    s_cmp_lg_u32 s51, 5
    s_cbranch_scc1 L_tk86
    s_call_b64 s[52:53], L_publish
L_tk86:
    s_cmp_le_u32 s23, 129032
    s_cbranch_scc1 L_tk87
    s_call_b64 s[54:55], L_list
L_tk87:
    s_waitcnt vmcnt(0)
    s_sleep 10
    s_cmp_lg_u32 s51, 6
    s_cbranch_scc1 L_tk88
    s_call_b64 s[52:53], L_publish
L_tk88:
    s_cmp_le_u32 s23, 129032
    s_cbranch_scc1 L_tk89
    s_call_b64 s[54:55], L_list
L_tk89:
    s_waitcnt vmcnt(0)
    s_sleep 10
    s_cmp_lg_u32 s51, 7
    s_cbranch_scc1 L_tk90
    s_call_b64 s[52:53], L_publish
L_tk90:
    s_cmp_le_u32 s23, 129032
    s_cbranch_scc1 L_tk91
    s_call_b64 s[54:55], L_list
L_tk91:
    s_waitcnt vmcnt(0)
    s_sleep 10
    s_cmp_lg_u32 s51, 8
    s_cbranch_scc1 L_tk92
    s_call_b64 s[52:53], L_publish
L_tk92:
    s_cmp_le_u32 s23, 129032
    s_cbranch_scc1 L_tk93
    s_call_b64 s[54:55], L_list
L_tk93:
    s_waitcnt vmcnt(0)
    s_sleep 10
    s_cmp_lg_u32 s51, 9
    s_cbranch_scc1 L_tk94
    s_call_b64 s[52:53], L_publish
L_tk94:
    s_cmp_le_u32 s23, 129032
    s_cbranch_scc1 L_tk95
    s_call_b64 s[54:55], L_list
L_tk95:
    s_waitcnt vmcnt(0)
    s_sleep 10
    s_cmp_lg_u32 s51, 10
    s_cbranch_scc1 L_tk96
    s_call_b64 s[52:53], L_publish
L_tk96:
    s_cmp_le_u32 s23, 129032
    s_cbranch_scc1 L_tk97
    s_call_b64 s[54:55], L_list
L_tk97:
    s_waitcnt vmcnt(0)
    s_sleep 10
    s_cmp_le_u32 s23, 129032
    s_cbranch_scc1 L_tk98
    s_call_b64 s[54:55], L_list
L_tk98:
    s_waitcnt vmcnt(0)
    s_sleep 10
    s_cmp_le_u32 s23, 129032
    s_cbranch_scc1 L_tk99
    s_call_b64 s[54:55], L_list
L_tk99:
    s_waitcnt vmcnt(0)
    s_sleep 10
    s_cmp_le_u32 s23, 129032
    s_cbranch_scc1 L_tk100
    s_call_b64 s[54:55], L_list
L_tk100:
    s_waitcnt vmcnt(0)
    s_sleep 10
    s_cmp_le_u32 s23, 129032
    s_cbranch_scc1 L_tk101
    s_call_b64 s[54:55], L_list
L_tk101:
    s_waitcnt vmcnt(0)
    s_sleep 10
    s_cmp_le_u32 s23, 129032
    s_cbranch_scc1 L_tk102
    s_call_b64 s[54:55], L_list
L_tk102:
    s_waitcnt vmcnt(0)
    s_sleep 10
L_nom137:
L_fill103:
    s_cmp_le_u32 s23, 129032
    s_cbranch_scc1 L_filled104
    s_sleep 8
    s_call_b64 s[54:55], L_list
    s_branch L_fill103
L_filled104:
    s_lshl_b32 s71, s66, 7
    s_add_u32 s70, s71, 2031616
    s_mov_b32 m0, s77
    s_nop 0
    buffer_load_dwordx4 v236, s[36:39], s70 offen offset:0  lds
    buffer_load_dwordx4 v237, s[36:39], s70 offen offset:1024  lds
    buffer_load_dwordx4 v238, s[36:39], s70 offen offset:2048  lds
    buffer_load_dwordx4 v239, s[36:39], s70 offen offset:3072  lds
    s_sub_u32 s70, s76, 1
    s_cselect_b32 s70, 24, s70
    s_cselect_b32 s75, 1, 3
    s_cselect_b32 s51, 31, 24
    s_lshl_b32 s74, s70, 12
    s_lshl_b32 s73, s70, 16
    s_add_u32 s73, s73, s71
    s_lshl_b32 s75, s75, 12
    s_lshl_b32 s51, s51, 12
L_wo105:
    s_mov_b32 m0, s74
    s_add_u32 s74, s74, s75
    buffer_load_dwordx4 v236, s[36:39], s73 offen offset:0  lds
    s_waitcnt vmcnt(5)
    buffer_load_dwordx4 v237, s[36:39], s73 offen offset:1024  lds
    s_waitcnt vmcnt(5)
    buffer_load_dwordx4 v238, s[36:39], s73 offen offset:2048  lds
    s_waitcnt vmcnt(5)
    buffer_load_dwordx4 v239, s[36:39], s73 offen offset:3072  lds
    s_waitcnt vmcnt(5)
    s_lshl_b32 s70, s75, 4
    s_add_u32 s73, s73, s70
    s_cmp_ge_u32 s3, 224
    s_cbranch_scc1 L_nomoe36
    s_lshr_b32 s70, s3, 3
    s_lshl_b32 s70, s70, 7
    s_add_u32 s70, s70, 0x234000
    s_mov_b32 s84, 100000
L_poll106:
    buffer_load_dword v215, v221, s[32:35], s70 offen sc1
    s_waitcnt vmcnt(0)
    v_cmp_ne_u32 vcc, s63, v215
    s_cbranch_vccz L_pdone107
    s_sub_u32 s84, s84, 1
    s_cbranch_scc1 L_pdone107
    s_sleep 32
    s_branch L_poll106
L_pdone107:
    s_lshl_b32 s70, s3, 6
    s_add_u32 s70, s70, 0x40000
    s_add_u32 s71, s70, 14336
    buffer_load_dword v100, v220, s[32:35], s70 offen sc1
    s_add_u32 s70, s70, 114688
    buffer_load_dword v108, v220, s[32:35], s71 offen sc1
    s_add_u32 s71, s71, 114688
    buffer_load_dword v101, v220, s[32:35], s70 offen sc1
    s_add_u32 s70, s70, 114688
    buffer_load_dword v109, v220, s[32:35], s71 offen sc1
    s_add_u32 s71, s71, 114688
    buffer_load_dword v102, v220, s[32:35], s70 offen sc1
    s_add_u32 s70, s70, 114688
    buffer_load_dword v110, v220, s[32:35], s71 offen sc1
    s_add_u32 s71, s71, 114688
    buffer_load_dword v103, v220, s[32:35], s70 offen sc1
    s_add_u32 s70, s70, 114688
    buffer_load_dword v111, v220, s[32:35], s71 offen sc1
    s_add_u32 s71, s71, 114688
    buffer_load_dword v104, v220, s[32:35], s70 offen sc1
    s_add_u32 s70, s70, 114688
    buffer_load_dword v112, v220, s[32:35], s71 offen sc1
    s_add_u32 s71, s71, 114688
    buffer_load_dword v105, v220, s[32:35], s70 offen sc1
    s_add_u32 s70, s70, 114688
    buffer_load_dword v113, v220, s[32:35], s71 offen sc1
    s_add_u32 s71, s71, 114688
    buffer_load_dword v106, v220, s[32:35], s70 offen sc1
    s_add_u32 s70, s70, 114688
    buffer_load_dword v114, v220, s[32:35], s71 offen sc1
    s_add_u32 s71, s71, 114688
    buffer_load_dword v107, v220, s[32:35], s70 offen sc1
    buffer_load_dword v115, v220, s[32:35], s71 offen sc1
    s_waitcnt vmcnt(0)
    s_setprio 1
    v_add_f32 v100, v100, v101
    v_add_f32 v108, v108, v109
    v_add_f32 v100, v100, v102
    v_add_f32 v108, v108, v110
    v_add_f32 v100, v100, v103
    v_add_f32 v108, v108, v111
    v_add_f32 v100, v100, v104
    v_add_f32 v108, v108, v112
    v_add_f32 v100, v100, v105
    v_add_f32 v108, v108, v113
    v_add_f32 v100, v100, v106
    v_add_f32 v108, v108, v114
    v_add_f32 v100, v100, v107
    v_add_f32 v108, v108, v115
    v_mov_b32 v214, v100
    v_mov_b32 v215, v108
    s_nop 0
    v_permlane32_swap_b32 v214, v100
    v_permlane32_swap_b32 v215, v108
    v_add_f32 v100, v100, v214
    v_add_f32 v108, v108, v215
    v_mov_b32 v214, v100
    v_mov_b32 v215, v108
    s_nop 0
    v_permlane16_swap_b32 v214, v100
    v_permlane16_swap_b32 v215, v108
    v_add_f32 v100, v100, v214
    v_add_f32 v108, v108, v215
    v_cvt_pk_bf16_f32 v214, v100, v108
    v_lshlrev_b32 v100, 16, v214
    v_and_b32 v108, s64, v214
    v_mul_f32 v214, 0xbfb8aa3b, v100
    v_exp_f32 v214, v214
    s_nop 0
    v_add_f32 v214, 1.0, v214
    v_rcp_f32 v214, v214
    s_nop 0
    v_mul_f32 v100, v100, v214
    v_cvt_pk_bf16_f32 v214, v100, v100
    v_and_b32 v100, s64, v214
    v_mul_f32 v100, v100, v108
    v_cvt_pk_bf16_f32 v100, v100, v100
    ds_bpermute_b32 v232, v240, v100 offset:0
    ds_bpermute_b32 v233, v240, v100 offset:4
    ds_bpermute_b32 v234, v240, v100 offset:8
    ds_bpermute_b32 v235, v240, v100 offset:12
    s_lshl_b32 s70, s3, 12
    s_lshl_b32 s71, s76, 10
    s_add_u32 s70, s70, s71
    s_add_u32 s70, s70, 0x140000
    s_lshl_b32 s72, s3, 2
    s_add_u32 s72, s72, s71
    s_add_u32 s72, s72, 0x236000
    s_waitcnt lgkmcnt(0)
    v_and_b32 v116, v232, v210
    v_and_b32 v117, v232, v211
    v_and_b32 v118, v232, v212
    v_and_b32 v119, v232, v213
    s_nop 1
    v_mfma_f32_16x16x32_bf16 v[224:227], v[116:119], v[68:71], 0
    v_mfma_f32_16x16x32_bf16 v[228:231], v[116:119], v[72:75], 0
    v_and_b32 v120, v233, v210
    v_and_b32 v121, v233, v211
    v_and_b32 v122, v233, v212
    v_and_b32 v123, v233, v213
    s_nop 1
    v_mfma_f32_16x16x32_bf16 v[224:227], v[120:123], v[76:79], v[224:227]
    v_mfma_f32_16x16x32_bf16 v[228:231], v[120:123], v[80:83], v[228:231]
    v_and_b32 v116, v234, v210
    v_and_b32 v117, v234, v211
    v_and_b32 v118, v234, v212
    v_and_b32 v119, v234, v213
    s_nop 1
    v_mfma_f32_16x16x32_bf16 v[224:227], v[116:119], v[84:87], v[224:227]
    v_mfma_f32_16x16x32_bf16 v[228:231], v[116:119], v[88:91], v[228:231]
    v_and_b32 v120, v235, v210
    v_and_b32 v121, v235, v211
    v_and_b32 v122, v235, v212
    v_and_b32 v123, v235, v213
    s_nop 1
    v_mfma_f32_16x16x32_bf16 v[224:227], v[120:123], v[92:95], v[224:227]
    v_mfma_f32_16x16x32_bf16 v[228:231], v[120:123], v[96:99], v[228:231]
    s_nop 6
    s_mov_b64 exec, 0xffffffff
    buffer_store_dwordx4 v[224:227], v222, s[32:35], s70 offen offset:0 sc1
    buffer_store_dwordx4 v[228:231], v222, s[32:35], s70 offen offset:512 sc1
    s_mov_b64 exec, -1
    v_mov_b32 v218, s63
    v_mov_b32 v219, 0
    s_waitcnt vmcnt(0)
    s_mov_b64 exec, 1
    buffer_store_dword v218, v219, s[32:35], s72 offen sc1
    s_mov_b64 exec, -1
    s_setprio 0
L_nomoe36:
L_wo108:
    s_mov_b32 m0, s74
    s_add_u32 s74, s74, s75
    buffer_load_dwordx4 v236, s[36:39], s73 offen offset:0  lds
    s_waitcnt vmcnt(5)
    buffer_load_dwordx4 v237, s[36:39], s73 offen offset:1024  lds
    s_waitcnt vmcnt(5)
    buffer_load_dwordx4 v238, s[36:39], s73 offen offset:2048  lds
    s_waitcnt vmcnt(5)
    buffer_load_dwordx4 v239, s[36:39], s73 offen offset:3072  lds
    s_waitcnt vmcnt(5)
    s_lshl_b32 s70, s75, 4
    s_add_u32 s73, s73, s70
    s_cmp_lt_u32 s74, s51
    s_cbranch_scc1 L_wo108
    ds_read_b64_tr_b16 v[188:189], v242 offset:0
    ds_read_b64_tr_b16 v[190:191], v242 offset:1024
    ds_read_b64_tr_b16 v[192:193], v243 offset:0
    ds_read_b64_tr_b16 v[194:195], v243 offset:1024
    ds_read_b64_tr_b16 v[196:197], v242 offset:2048
    ds_read_b64_tr_b16 v[198:199], v242 offset:3072
    ds_read_b64_tr_b16 v[200:201], v243 offset:2048
    ds_read_b64_tr_b16 v[202:203], v243 offset:3072
    s_waitcnt vmcnt(0) lgkmcnt(0)
    v_mov_b32 v214, 1
    s_mov_b64 exec, 1
    ds_add_u32 v249, v214 offset:4
    s_mov_b64 exec, -1
    s_and_b32 s74, s69, 0x7ff
    s_sub_u32 s74, 2047, s74
    s_lshr_b32 s70, s74, 7
    s_cmp_lg_u32 s70, s65
    s_cbranch_scc1 L_noown109
    s_lshr_b32 s70, s66, 2
    s_lshl_b32 s70, s70, 10
    s_add_u32 s70, s70, 0x236000
    s_mov_b32 s84, 100000
L_poll110:
    buffer_load_dwordx4 v[4:7], v206, s[32:35], s70 offen sc1
    s_waitcnt vmcnt(0)
    v_xor_b32 v4, s63, v4
    v_xor_b32 v5, s63, v5
    v_xor_b32 v6, s63, v6
    v_xor_b32 v7, s63, v7
    v_or3_b32 v4, v4, v5, v6
    v_or_b32 v4, v4, v7
    v_cmp_ne_u32 vcc, 0, v4
    s_cbranch_vccz L_pdone111
    s_sub_u32 s84, s84, 1
    s_cbranch_scc1 L_pdone111
    s_sleep 32
    s_branch L_poll110
L_pdone111:
    s_mul_i32 s70, s76, 229376
    s_lshl_b32 s71, s66, 8
    s_add_u32 s70, s70, s71
    s_add_u32 s70, s70, 0x140000
    buffer_load_dwordx4 v[4:7], v241, s[32:35], s70 offen sc1
    s_add_u32 s70, s70, 16384
    buffer_load_dwordx4 v[8:11], v241, s[32:35], s70 offen sc1
    s_add_u32 s70, s70, 16384
    buffer_load_dwordx4 v[12:15], v241, s[32:35], s70 offen sc1
    s_add_u32 s70, s70, 16384
    buffer_load_dwordx4 v[16:19], v241, s[32:35], s70 offen sc1
    s_add_u32 s70, s70, 16384
    buffer_load_dwordx4 v[20:23], v241, s[32:35], s70 offen sc1
    s_add_u32 s70, s70, 16384
    buffer_load_dwordx4 v[24:27], v241, s[32:35], s70 offen sc1
    s_add_u32 s70, s70, 16384
    buffer_load_dwordx4 v[28:31], v241, s[32:35], s70 offen sc1
    s_add_u32 s70, s70, 16384
    buffer_load_dwordx4 v[32:35], v241, s[32:35], s70 offen sc1
    s_add_u32 s70, s70, 16384
    buffer_load_dwordx4 v[36:39], v241, s[32:35], s70 offen sc1
    s_add_u32 s70, s70, 16384
    buffer_load_dwordx4 v[40:43], v241, s[32:35], s70 offen sc1
    s_add_u32 s70, s70, 16384
    buffer_load_dwordx4 v[44:47], v241, s[32:35], s70 offen sc1
    s_add_u32 s70, s70, 16384
    buffer_load_dwordx4 v[48:51], v241, s[32:35], s70 offen sc1
    s_add_u32 s70, s70, 16384
    buffer_load_dwordx4 v[52:55], v241, s[32:35], s70 offen sc1
    s_add_u32 s70, s70, 16384
    buffer_load_dwordx4 v[56:59], v241, s[32:35], s70 offen sc1
    s_add_u32 s70, s70, 16384
    v_and_b32 v149, s64, v168
    v_lshlrev_b32 v148, 16, v168
    v_and_b32 v151, s64, v169
    v_lshlrev_b32 v150, 16, v169
    v_and_b32 v153, s64, v170
    v_lshlrev_b32 v152, 16, v170
    v_and_b32 v155, s64, v171
    v_lshlrev_b32 v154, 16, v171
    v_and_b32 v157, s64, v172
    v_lshlrev_b32 v156, 16, v172
    v_and_b32 v159, s64, v173
    v_lshlrev_b32 v158, 16, v173
    v_and_b32 v161, s64, v174
    v_lshlrev_b32 v160, 16, v174
    v_and_b32 v163, s64, v175
    v_lshlrev_b32 v162, 16, v175
    v_fma_f32 v148, v148, v167, -v166
    v_fma_f32 v149, v149, v167, -v166
    v_fma_f32 v150, v150, v167, -v166
    v_fma_f32 v151, v151, v167, -v166
    v_fma_f32 v152, v152, v167, -v166
    v_fma_f32 v153, v153, v167, -v166
    v_fma_f32 v154, v154, v167, -v166
    v_fma_f32 v155, v155, v167, -v166
    v_fma_f32 v156, v156, v167, -v166
    v_fma_f32 v157, v157, v167, -v166
    v_fma_f32 v158, v158, v167, -v166
    v_fma_f32 v159, v159, v167, -v166
    v_fma_f32 v160, v160, v167, -v166
    v_fma_f32 v161, v161, v167, -v166
    v_fma_f32 v162, v162, v167, -v166
    v_fma_f32 v163, v163, v167, -v166
    v_and_b32 v133, s64, v176
    v_lshlrev_b32 v132, 16, v176
    v_and_b32 v135, s64, v177
    v_lshlrev_b32 v134, 16, v177
    v_and_b32 v137, s64, v178
    v_lshlrev_b32 v136, 16, v178
    v_and_b32 v139, s64, v179
    v_lshlrev_b32 v138, 16, v179
    v_and_b32 v141, s64, v180
    v_lshlrev_b32 v140, 16, v180
    v_and_b32 v143, s64, v181
    v_lshlrev_b32 v142, 16, v181
    v_and_b32 v145, s64, v182
    v_lshlrev_b32 v144, 16, v182
    v_and_b32 v147, s64, v183
    v_lshlrev_b32 v146, 16, v183
    v_fma_f32 v132, v132, v167, -v166
    v_fma_f32 v133, v133, v167, -v166
    v_fma_f32 v134, v134, v167, -v166
    v_fma_f32 v135, v135, v167, -v166
    v_fma_f32 v136, v136, v167, -v166
    v_fma_f32 v137, v137, v167, -v166
    v_fma_f32 v138, v138, v167, -v166
    v_fma_f32 v139, v139, v167, -v166
    v_fma_f32 v140, v140, v167, -v166
    v_fma_f32 v141, v141, v167, -v166
    v_fma_f32 v142, v142, v167, -v166
    v_fma_f32 v143, v143, v167, -v166
    v_fma_f32 v144, v144, v167, -v166
    v_fma_f32 v145, v145, v167, -v166
    v_fma_f32 v146, v146, v167, -v166
    v_fma_f32 v147, v147, v167, -v166
    s_mov_b32 s84, 800000
    ds_read_b32 v214, v249 offset:8
L_lw112:
    s_waitcnt lgkmcnt(0)
    v_cmp_ne_u32 vcc, 4, v214
    s_cbranch_vccz L_lwd113
    s_sub_u32 s84, s84, 1
    s_cbranch_scc1 L_lwd113
    s_sleep 4
    ds_read_b32 v214, v249 offset:8
    s_branch L_lw112
L_lwd113:
    s_waitcnt vmcnt(0)
    v_pk_add_f32 v[4:5], v[4:5], v[8:9]
    v_pk_add_f32 v[6:7], v[6:7], v[10:11]
    v_pk_add_f32 v[4:5], v[4:5], v[12:13]
    v_pk_add_f32 v[6:7], v[6:7], v[14:15]
    v_pk_add_f32 v[4:5], v[4:5], v[16:17]
    v_pk_add_f32 v[6:7], v[6:7], v[18:19]
    v_pk_add_f32 v[4:5], v[4:5], v[20:21]
    v_pk_add_f32 v[6:7], v[6:7], v[22:23]
    v_pk_add_f32 v[4:5], v[4:5], v[24:25]
    v_pk_add_f32 v[6:7], v[6:7], v[26:27]
    v_pk_add_f32 v[4:5], v[4:5], v[28:29]
    v_pk_add_f32 v[6:7], v[6:7], v[30:31]
    v_pk_add_f32 v[4:5], v[4:5], v[32:33]
    v_pk_add_f32 v[6:7], v[6:7], v[34:35]
    v_pk_add_f32 v[4:5], v[4:5], v[36:37]
    v_pk_add_f32 v[6:7], v[6:7], v[38:39]
    v_pk_add_f32 v[4:5], v[4:5], v[40:41]
    v_pk_add_f32 v[6:7], v[6:7], v[42:43]
    v_pk_add_f32 v[4:5], v[4:5], v[44:45]
    v_pk_add_f32 v[6:7], v[6:7], v[46:47]
    v_pk_add_f32 v[4:5], v[4:5], v[48:49]
    v_pk_add_f32 v[6:7], v[6:7], v[50:51]
    v_pk_add_f32 v[4:5], v[4:5], v[52:53]
    v_pk_add_f32 v[6:7], v[6:7], v[54:55]
    v_pk_add_f32 v[4:5], v[4:5], v[56:57]
    v_pk_add_f32 v[6:7], v[6:7], v[58:59]
    v_mov_b32 v60, v4
    v_mov_b32 v61, v5
    v_mov_b32 v62, v6
    v_mov_b32 v63, v7
    s_nop 0
    v_permlane32_swap_b32 v60, v4
    v_permlane32_swap_b32 v61, v5
    v_permlane32_swap_b32 v62, v6
    v_permlane32_swap_b32 v63, v7
    v_add_f32 v4, v4, v60
    v_add_f32 v5, v5, v61
    v_add_f32 v6, v6, v62
    v_add_f32 v7, v7, v63
    v_mov_b32 v60, v4
    v_mov_b32 v61, v5
    v_mov_b32 v62, v6
    v_mov_b32 v63, v7
    s_nop 0
    v_permlane16_swap_b32 v60, v4
    v_permlane16_swap_b32 v61, v5
    v_permlane16_swap_b32 v62, v6
    v_permlane16_swap_b32 v63, v7
    v_add_f32 v4, v4, v60
    v_add_f32 v5, v5, v61
    v_add_f32 v6, v6, v62
    v_add_f32 v7, v7, v63
    s_lshl_b32 s70, s76, 8
    s_add_u32 s70, s70, 129536
    v_add_u32 v214, s70, v205
    ds_write_b128 v214, v[4:7]
    s_waitcnt lgkmcnt(0)
    v_mov_b32 v214, 1
    s_mov_b64 exec, 1
    ds_add_u32 v249, v214 offset:32
    s_mov_b64 exec, -1
    s_lshr_b32 s70, s74, 5
    s_cmp_lg_u32 s70, s68
    s_cbranch_scc1 L_noown109x
    s_mov_b32 s84, 800000
    ds_read_b32 v214, v249 offset:32
L_lw114:
    s_waitcnt lgkmcnt(0)
    v_cmp_ne_u32 vcc, 4, v214
    s_cbranch_vccz L_lwd115
    s_sub_u32 s84, s84, 1
    s_cbranch_scc1 L_lwd115
    ds_read_b32 v214, v249 offset:32
    s_branch L_lw114
L_lwd115:
    v_add_u32 v214, 129536, v205
    ds_read_b128 v[40:43], v214 offset:0
    ds_read_b128 v[44:47], v214 offset:256
    ds_read_b128 v[48:51], v214 offset:512
    ds_read_b128 v[52:55], v214 offset:768
    s_lshr_b32 s71, s69, 16
    s_bitcmp1_b32 s71, 15
    s_cselect_b32 s72, 0, 0x7fff
    s_xor_b32 s71, s71, s72
    s_xor_b32 s71, s71, 0x8000
    s_lshl_b32 s71, s71, 16
    v_mov_b32 v215, s71
    v_mul_f32 v215, 0xbfb8aa3b, v215
    v_exp_f32 v215, v215
    s_nop 0
    v_add_f32 v215, 1.0, v215
    v_rcp_f32 v215, v215
    s_nop 0
    v_cvt_pk_bf16_f32 v215, v215, v215
    v_and_b32 v215, s64, v215
    s_waitcnt lgkmcnt(0)
    v_add_f32 v40, v40, v44
    v_add_f32 v41, v41, v45
    v_add_f32 v42, v42, v46
    v_add_f32 v43, v43, v47
    v_add_f32 v40, v40, v48
    v_add_f32 v41, v41, v49
    v_add_f32 v42, v42, v50
    v_add_f32 v43, v43, v51
    v_add_f32 v40, v40, v52
    v_add_f32 v41, v41, v53
    v_add_f32 v42, v42, v54
    v_add_f32 v43, v43, v55
    v_cvt_pk_bf16_f32 v4, v40, v41
    v_lshlrev_b32 v40, 16, v4
    v_and_b32 v41, s64, v4
    v_cvt_pk_bf16_f32 v4, v42, v43
    v_lshlrev_b32 v42, 16, v4
    v_and_b32 v43, s64, v4
    v_mul_f32 v40, v215, v40
    v_mul_f32 v41, v215, v41
    v_mul_f32 v42, v215, v42
    v_mul_f32 v43, v215, v43
    v_cvt_pk_bf16_f32 v4, v40, v41
    v_lshlrev_b32 v40, 16, v4
    v_and_b32 v41, s64, v4
    v_cvt_pk_bf16_f32 v4, v42, v43
    v_lshlrev_b32 v42, 16, v4
    v_and_b32 v43, s64, v4
    ds_write_b128 v214, v[40:43]
    v_and_b32 v214, 32, v1
    v_lshlrev_b32 v214, 1, v214
    v_add_u32 v214, 129536, v214
    s_waitcnt lgkmcnt(0)
    ds_read_b128 v[4:7], v214 offset:0
    ds_read_b128 v[8:11], v214 offset:16
    ds_read_b128 v[12:15], v214 offset:32
    ds_read_b128 v[16:19], v214 offset:48
    ds_read_b128 v[20:23], v214 offset:128
    ds_read_b128 v[24:27], v214 offset:144
    ds_read_b128 v[28:31], v214 offset:160
    ds_read_b128 v[32:35], v214 offset:176
    s_and_b32 s74, s74, 31
    s_lshl_b32 s74, 1, s74
    s_waitcnt lgkmcnt(0)
    s_mov_b32 exec_lo, s74
    s_mov_b32 exec_hi, s74
    v_add_f32 v148, v148, v4
    v_add_f32 v149, v149, v5
    v_add_f32 v150, v150, v6
    v_add_f32 v151, v151, v7
    v_add_f32 v152, v152, v8
    v_add_f32 v153, v153, v9
    v_add_f32 v154, v154, v10
    v_add_f32 v155, v155, v11
    v_add_f32 v156, v156, v12
    v_add_f32 v157, v157, v13
    v_add_f32 v158, v158, v14
    v_add_f32 v159, v159, v15
    v_add_f32 v160, v160, v16
    v_add_f32 v161, v161, v17
    v_add_f32 v162, v162, v18
    v_add_f32 v163, v163, v19
    v_add_f32 v132, v132, v20
    v_add_f32 v133, v133, v21
    v_add_f32 v134, v134, v22
    v_add_f32 v135, v135, v23
    v_add_f32 v136, v136, v24
    v_add_f32 v137, v137, v25
    v_add_f32 v138, v138, v26
    v_add_f32 v139, v139, v27
    v_add_f32 v140, v140, v28
    v_add_f32 v141, v141, v29
    v_add_f32 v142, v142, v30
    v_add_f32 v143, v143, v31
    v_add_f32 v144, v144, v32
    v_add_f32 v145, v145, v33
    v_add_f32 v146, v146, v34
    v_add_f32 v147, v147, v35
    s_mov_b64 exec, -1
    s_branch L_noown109x
L_noown109:
    v_and_b32 v149, s64, v168
    v_lshlrev_b32 v148, 16, v168
    v_and_b32 v151, s64, v169
    v_lshlrev_b32 v150, 16, v169
    v_and_b32 v153, s64, v170
    v_lshlrev_b32 v152, 16, v170
    v_and_b32 v155, s64, v171
    v_lshlrev_b32 v154, 16, v171
    v_and_b32 v157, s64, v172
    v_lshlrev_b32 v156, 16, v172
    v_and_b32 v159, s64, v173
    v_lshlrev_b32 v158, 16, v173
    v_and_b32 v161, s64, v174
    v_lshlrev_b32 v160, 16, v174
    v_and_b32 v163, s64, v175
    v_lshlrev_b32 v162, 16, v175
    v_fma_f32 v148, v148, v167, -v166
    v_fma_f32 v149, v149, v167, -v166
    v_fma_f32 v150, v150, v167, -v166
    v_fma_f32 v151, v151, v167, -v166
    v_fma_f32 v152, v152, v167, -v166
    v_fma_f32 v153, v153, v167, -v166
    v_fma_f32 v154, v154, v167, -v166
    v_fma_f32 v155, v155, v167, -v166
    v_fma_f32 v156, v156, v167, -v166
    v_fma_f32 v157, v157, v167, -v166
    v_fma_f32 v158, v158, v167, -v166
    v_fma_f32 v159, v159, v167, -v166
    v_fma_f32 v160, v160, v167, -v166
    v_fma_f32 v161, v161, v167, -v166
    v_fma_f32 v162, v162, v167, -v166
    v_fma_f32 v163, v163, v167, -v166
    v_and_b32 v133, s64, v176
    v_lshlrev_b32 v132, 16, v176
    v_and_b32 v135, s64, v177
    v_lshlrev_b32 v134, 16, v177
    v_and_b32 v137, s64, v178
    v_lshlrev_b32 v136, 16, v178
    v_and_b32 v139, s64, v179
    v_lshlrev_b32 v138, 16, v179
    v_and_b32 v141, s64, v180
    v_lshlrev_b32 v140, 16, v180
    v_and_b32 v143, s64, v181
    v_lshlrev_b32 v142, 16, v181
    v_and_b32 v145, s64, v182
    v_lshlrev_b32 v144, 16, v182
    v_and_b32 v147, s64, v183
    v_lshlrev_b32 v146, 16, v183
    v_fma_f32 v132, v132, v167, -v166
    v_fma_f32 v133, v133, v167, -v166
    v_fma_f32 v134, v134, v167, -v166
    v_fma_f32 v135, v135, v167, -v166
    v_fma_f32 v136, v136, v167, -v166
    v_fma_f32 v137, v137, v167, -v166
    v_fma_f32 v138, v138, v167, -v166
    v_fma_f32 v139, v139, v167, -v166
    v_fma_f32 v140, v140, v167, -v166
    v_fma_f32 v141, v141, v167, -v166
    v_fma_f32 v142, v142, v167, -v166
    v_fma_f32 v143, v143, v167, -v166
    v_fma_f32 v144, v144, v167, -v166
    v_fma_f32 v145, v145, v167, -v166
    v_fma_f32 v146, v146, v167, -v166
    v_fma_f32 v147, v147, v167, -v166
L_noown109x:
    s_add_u32 s20, s20, s83
    s_addc_u32 s21, s21, 0
    s_lshl_b32 s72, s62, 12
    s_add_u32 s72, s72, 131072
    v_add_u32 v247, s72, v2
    v_xor_b32 v248, 16384, v247
    s_xor_b32 s72, s72, 16384
    v_and_b32 v232, 31, v1
    v_lshlrev_b32 v232, 6, v232
    v_and_b32 v233, 32, v1
    v_add3_u32 v232, v232, v233, s72
    v_lshrrev_b32 v233, 2, v1
    v_lshlrev_b32 v233, 11, v233
    v_and_or_b32 v233, v2, 48, v233
    s_lshl_b32 s72, s67, 6
    s_add_u32 s81, s81, s72
    s_add_u32 s83, s81, 32768
    s_mov_b32 s84, 800000
    ds_read_b32 v214, v249 offset:4
L_lw116:
    s_waitcnt lgkmcnt(0)
    v_cmp_ne_u32 vcc, 4, v214
    s_cbranch_vccz L_lwd117
    s_sub_u32 s84, s84, 1
    s_cbranch_scc1 L_lwd117
    s_sleep 8
    ds_read_b32 v214, v249 offset:4
    s_branch L_lw116
L_lwd117:
    s_mov_b32 s84, 800000
    ds_read_b32 v214, v249 offset:16
L_lw118:
    s_waitcnt lgkmcnt(0)
    v_cmp_ne_u32 vcc, 1, v214
    s_cbranch_vccz L_lwd119
    s_sub_u32 s84, s84, 1
    s_cbranch_scc1 L_lwd119
    s_sleep 4
    ds_read_b32 v214, v249 offset:16
    s_branch L_lw118
L_lwd119:
    s_setprio 1
    s_branch L_proj
L_lwp:
    s_mov_b32 s84, 800000
L_lsp:
    ds_read_b32 v231, v230
    s_waitcnt lgkmcnt(0)
    v_readlane_b32 s79, v231, s80
    s_nop 0
    s_cmp_lg_u32 s79, -1
    s_cbranch_scc1 L_lop
    s_sleep 1
    s_sub_u32 s84, s84, 1
    s_cbranch_scc0 L_lsp
    s_branch L_lop
L_lwh0:
    s_mov_b32 s84, 800000
L_lsh0:
    ds_read_b32 v231, v230
    s_waitcnt lgkmcnt(0)
    v_readlane_b32 s79, v231, s80
    s_nop 0
    s_cmp_lg_u32 s79, -1
    s_cbranch_scc1 L_loh0
    s_sleep 1
    s_sub_u32 s84, s84, 1
    s_cbranch_scc0 L_lsh0
    s_branch L_loh0
L_lwh1:
    s_mov_b32 s84, 800000
L_lsh1:
    ds_read_b32 v231, v230
    s_waitcnt lgkmcnt(0)
    v_readlane_b32 s79, v231, s80
    s_nop 0
    s_cmp_lg_u32 s79, -1
    s_cbranch_scc1 L_loh1
    s_sleep 1
    s_sub_u32 s84, s84, 1
    s_cbranch_scc0 L_lsh1
    s_branch L_loh1
L_hand:
    s_setprio 2
    ds_read_b32 v231, v249 offset:4
    ds_read_b32 v232, v249 offset:36
    s_lshl_b32 s70, s62, 13
    s_add_u32 s70, s70, 131072
    v_add_u32 v228, s70, v2
    s_lshl_b32 s70, s62, 9
    s_sub_u32 s70, s70, 2048
    v_add_u32 v229, s70, v230
    s_lshl_b32 s70, s62, 2
    v_add_u32 v230, s70, v249
    s_mov_b32 s84, 800000
L_lw1:
    s_waitcnt lgkmcnt(0)
    v_cmp_ne_u32 vcc, 4, v231
    s_cbranch_vccz L_lwd2
    s_sub_u32 s84, s84, 1
    s_cbranch_scc1 L_lwd2
    s_sleep 1
    ds_read_b32 v231, v249 offset:4
    s_branch L_lw1
L_lwd2:
    v_readfirstlane_b32 s63, v232
    ds_write_b128 v228, v[132:135] offset:0
    ds_write_b128 v228, v[136:139] offset:1024
    ds_write_b128 v228, v[140:143] offset:2048
    ds_write_b128 v228, v[144:147] offset:3072
    ds_write_b32 v229, v60 offset:0
    ds_write_b128 v228, v[148:151] offset:4096
    ds_write_b128 v228, v[152:155] offset:5120
    ds_write_b128 v228, v[156:159] offset:6144
    ds_write_b128 v228, v[160:163] offset:7168
    ds_write_b32 v229, v64 offset:256
    v_xor_b32 v228, 16384, v228
    v_xor_b32 v229, 1024, v229
    v_mov_b32 v232, 1
    ds_write_b32 v230, v232 offset:16
    v_xor_b32 v230, 8, v230
    s_branch L_handed
L_exact:
    s_lshl_b32 s72, s61, 4
    s_add_u32 s72, s72, s60
    s_lshl_b32 s72, s72, 7
    s_add_u32 s72, s72, 0x2a0000
    v_and_b32 v228, 15, v1
    v_lshlrev_b32 v228, 2, v228
    s_mov_b32 s84, 100000
L_poll3:
    buffer_load_dword v229, v228, s[32:35], s72 offen sc1
    s_waitcnt vmcnt(0)
    v_cmp_ne_u32 vcc, s63, v229
    s_cbranch_vccz L_pdone4
    s_sub_u32 s84, s84, 1
    s_cbranch_scc1 L_pdone4
    s_sleep 4
    s_branch L_poll3
L_pdone4:
    s_lshl_b32 s72, s77, 18
    s_add_u32 s73, s72, 0x700000
    s_add_u32 s72, s73, 0x40000
    v_mov_b32 v48, 0xff800000
    v_mov_b32 v44, 0
    v_mov_b32 v100, 0
    v_mov_b32 v101, 0
    v_mov_b32 v102, 0
    v_mov_b32 v103, 0
    v_mov_b32 v104, 0
    v_mov_b32 v105, 0
    v_mov_b32 v106, 0
    v_mov_b32 v107, 0
    v_mov_b32 v108, 0
    v_mov_b32 v109, 0
    v_mov_b32 v110, 0
    v_mov_b32 v111, 0
    v_mov_b32 v112, 0
    v_mov_b32 v113, 0
    v_mov_b32 v114, 0
    v_mov_b32 v115, 0
    v_mov_b32 v64, 0xff800000
    v_mov_b32 v60, 0
    v_mov_b32 v116, 0
    v_mov_b32 v117, 0
    v_mov_b32 v118, 0
    v_mov_b32 v119, 0
    v_mov_b32 v120, 0
    v_mov_b32 v121, 0
    v_mov_b32 v122, 0
    v_mov_b32 v123, 0
    v_mov_b32 v124, 0
    v_mov_b32 v125, 0
    v_mov_b32 v126, 0
    v_mov_b32 v127, 0
    v_mov_b32 v128, 0
    v_mov_b32 v129, 0
    v_mov_b32 v130, 0
    v_mov_b32 v131, 0
L_exact_loop:
    buffer_load_dwordx4 v[196:199], v2, s[32:35], s73 offen offset:0 sc1
    buffer_load_dwordx4 v[200:203], v2, s[32:35], s73 offen offset:1024 sc1
    buffer_load_dwordx4 v[204:207], v2, s[32:35], s73 offen offset:2048 sc1
    buffer_load_dwordx4 v[208:211], v2, s[32:35], s73 offen offset:3072 sc1
    s_waitcnt vmcnt(0)
    v_mfma_f32_32x32x16_bf16 v[164:179], v[196:199], v[4:7], 0
    v_mfma_f32_32x32x16_bf16 v[164:179], v[200:203], v[8:11], v[164:179]
    v_mfma_f32_32x32x16_bf16 v[180:195], v[196:199], v[20:23], 0
    v_mfma_f32_32x32x16_bf16 v[180:195], v[200:203], v[24:27], v[180:195]
    s_nop 7
    s_nop 3
    v_max3_f32 v228, v164, v165, v48
    v_max3_f32 v228, v166, v167, v228
    v_max3_f32 v228, v168, v169, v228
    v_max3_f32 v228, v170, v171, v228
    v_max3_f32 v228, v172, v173, v228
    v_max3_f32 v228, v174, v175, v228
    v_max3_f32 v228, v176, v177, v228
    v_max3_f32 v228, v178, v179, v228
    v_mov_b32 v229, v228
    s_nop 1
    v_permlane32_swap_b32 v229, v228
    v_max_f32 v228, v228, v229
    v_sub_f32 v229, v48, v228
    v_exp_f32 v229, v229
    v_mov_b32 v48, v228
    v_sub_f32 v164, v164, v228
    v_sub_f32 v165, v165, v228
    v_sub_f32 v166, v166, v228
    v_sub_f32 v167, v167, v228
    v_sub_f32 v168, v168, v228
    v_sub_f32 v169, v169, v228
    v_sub_f32 v170, v170, v228
    v_sub_f32 v171, v171, v228
    v_sub_f32 v172, v172, v228
    v_sub_f32 v173, v173, v228
    v_sub_f32 v174, v174, v228
    v_sub_f32 v175, v175, v228
    v_sub_f32 v176, v176, v228
    v_sub_f32 v177, v177, v228
    v_sub_f32 v178, v178, v228
    v_sub_f32 v179, v179, v228
    v_exp_f32 v164, v164
    v_exp_f32 v165, v165
    v_exp_f32 v166, v166
    v_exp_f32 v167, v167
    v_exp_f32 v168, v168
    v_exp_f32 v169, v169
    v_exp_f32 v170, v170
    v_exp_f32 v171, v171
    v_exp_f32 v172, v172
    v_exp_f32 v173, v173
    v_exp_f32 v174, v174
    v_exp_f32 v175, v175
    v_exp_f32 v176, v176
    v_exp_f32 v177, v177
    v_exp_f32 v178, v178
    v_exp_f32 v179, v179
    v_mul_f32 v44, v44, v229
    v_add_f32 v44, v44, v164
    v_mul_f32 v100, v100, v229
    v_add_f32 v44, v44, v165
    v_mul_f32 v101, v101, v229
    v_add_f32 v44, v44, v166
    v_mul_f32 v102, v102, v229
    v_add_f32 v44, v44, v167
    v_mul_f32 v103, v103, v229
    v_add_f32 v44, v44, v168
    v_mul_f32 v104, v104, v229
    v_add_f32 v44, v44, v169
    v_mul_f32 v105, v105, v229
    v_add_f32 v44, v44, v170
    v_mul_f32 v106, v106, v229
    v_add_f32 v44, v44, v171
    v_mul_f32 v107, v107, v229
    v_add_f32 v44, v44, v172
    v_mul_f32 v108, v108, v229
    v_add_f32 v44, v44, v173
    v_mul_f32 v109, v109, v229
    v_add_f32 v44, v44, v174
    v_mul_f32 v110, v110, v229
    v_add_f32 v44, v44, v175
    v_mul_f32 v111, v111, v229
    v_add_f32 v44, v44, v176
    v_mul_f32 v112, v112, v229
    v_add_f32 v44, v44, v177
    v_mul_f32 v113, v113, v229
    v_add_f32 v44, v44, v178
    v_mul_f32 v114, v114, v229
    v_add_f32 v44, v44, v179
    v_mul_f32 v115, v115, v229
    v_cvt_pk_bf16_f32 v76, v164, v165
    v_cvt_pk_bf16_f32 v77, v166, v167
    v_cvt_pk_bf16_f32 v78, v168, v169
    v_cvt_pk_bf16_f32 v79, v170, v171
    v_cvt_pk_bf16_f32 v80, v172, v173
    v_cvt_pk_bf16_f32 v81, v174, v175
    v_cvt_pk_bf16_f32 v82, v176, v177
    v_cvt_pk_bf16_f32 v83, v178, v179
    s_nop 1
    v_mfma_f32_32x32x16_bf16 v[100:115], v[204:207], v[76:79], v[100:115]
    v_mfma_f32_32x32x16_bf16 v[100:115], v[208:211], v[80:83], v[100:115]
    v_max3_f32 v228, v180, v181, v64
    v_max3_f32 v228, v182, v183, v228
    v_max3_f32 v228, v184, v185, v228
    v_max3_f32 v228, v186, v187, v228
    v_max3_f32 v228, v188, v189, v228
    v_max3_f32 v228, v190, v191, v228
    v_max3_f32 v228, v192, v193, v228
    v_max3_f32 v228, v194, v195, v228
    v_mov_b32 v229, v228
    s_nop 1
    v_permlane32_swap_b32 v229, v228
    v_max_f32 v228, v228, v229
    v_sub_f32 v229, v64, v228
    v_exp_f32 v229, v229
    v_mov_b32 v64, v228
    v_sub_f32 v180, v180, v228
    v_sub_f32 v181, v181, v228
    v_sub_f32 v182, v182, v228
    v_sub_f32 v183, v183, v228
    v_sub_f32 v184, v184, v228
    v_sub_f32 v185, v185, v228
    v_sub_f32 v186, v186, v228
    v_sub_f32 v187, v187, v228
    v_sub_f32 v188, v188, v228
    v_sub_f32 v189, v189, v228
    v_sub_f32 v190, v190, v228
    v_sub_f32 v191, v191, v228
    v_sub_f32 v192, v192, v228
    v_sub_f32 v193, v193, v228
    v_sub_f32 v194, v194, v228
    v_sub_f32 v195, v195, v228
    v_exp_f32 v180, v180
    v_exp_f32 v181, v181
    v_exp_f32 v182, v182
    v_exp_f32 v183, v183
    v_exp_f32 v184, v184
    v_exp_f32 v185, v185
    v_exp_f32 v186, v186
    v_exp_f32 v187, v187
    v_exp_f32 v188, v188
    v_exp_f32 v189, v189
    v_exp_f32 v190, v190
    v_exp_f32 v191, v191
    v_exp_f32 v192, v192
    v_exp_f32 v193, v193
    v_exp_f32 v194, v194
    v_exp_f32 v195, v195
    v_mul_f32 v60, v60, v229
    v_add_f32 v60, v60, v180
    v_mul_f32 v116, v116, v229
    v_add_f32 v60, v60, v181
    v_mul_f32 v117, v117, v229
    v_add_f32 v60, v60, v182
    v_mul_f32 v118, v118, v229
    v_add_f32 v60, v60, v183
    v_mul_f32 v119, v119, v229
    v_add_f32 v60, v60, v184
    v_mul_f32 v120, v120, v229
    v_add_f32 v60, v60, v185
    v_mul_f32 v121, v121, v229
    v_add_f32 v60, v60, v186
    v_mul_f32 v122, v122, v229
    v_add_f32 v60, v60, v187
    v_mul_f32 v123, v123, v229
    v_add_f32 v60, v60, v188
    v_mul_f32 v124, v124, v229
    v_add_f32 v60, v60, v189
    v_mul_f32 v125, v125, v229
    v_add_f32 v60, v60, v190
    v_mul_f32 v126, v126, v229
    v_add_f32 v60, v60, v191
    v_mul_f32 v127, v127, v229
    v_add_f32 v60, v60, v192
    v_mul_f32 v128, v128, v229
    v_add_f32 v60, v60, v193
    v_mul_f32 v129, v129, v229
    v_add_f32 v60, v60, v194
    v_mul_f32 v130, v130, v229
    v_add_f32 v60, v60, v195
    v_mul_f32 v131, v131, v229
    v_cvt_pk_bf16_f32 v76, v180, v181
    v_cvt_pk_bf16_f32 v77, v182, v183
    v_cvt_pk_bf16_f32 v78, v184, v185
    v_cvt_pk_bf16_f32 v79, v186, v187
    v_cvt_pk_bf16_f32 v80, v188, v189
    v_cvt_pk_bf16_f32 v81, v190, v191
    v_cvt_pk_bf16_f32 v82, v192, v193
    v_cvt_pk_bf16_f32 v83, v194, v195
    s_nop 1
    v_mfma_f32_32x32x16_bf16 v[116:131], v[204:207], v[76:79], v[116:131]
    v_mfma_f32_32x32x16_bf16 v[116:131], v[208:211], v[80:83], v[116:131]
    s_add_u32 s73, s73, 4096
    s_cmp_lt_u32 s73, s72
    s_cbranch_scc1 L_exact_loop
    v_mov_b32 v229, v44
    s_nop 1
    v_permlane32_swap_b32 v229, v44
    v_add_f32 v44, v44, v229
    v_mov_b32 v229, v60
    s_nop 1
    v_permlane32_swap_b32 v229, v60
    v_add_f32 v60, v60, v229
    s_nop 7
    s_branch L_exact_done
L_colsum:
    ds_read_b128 v[28:31], v172 offset:0
    ds_read_b128 v[32:35], v175 offset:1024
    ds_read_b128 v[36:39], v172 offset:6144
    ds_read_b128 v[40:43], v175 offset:7168
    ds_read_b128 v[44:47], v172 offset:12288
    ds_read_b128 v[48:51], v175 offset:13312
    ds_read_b128 v[52:55], v172 offset:18432
    ds_read_b128 v[56:59], v175 offset:19456
    s_setprio 1
    s_waitcnt lgkmcnt(7)
    v_mfma_f32_16x16x32_bf16 v[128:131], v[124:127], v[28:31], 0
    s_waitcnt lgkmcnt(6)
    v_mfma_f32_16x16x32_bf16 v[128:131], v[124:127], v[32:35], v[128:131]
    s_waitcnt lgkmcnt(5)
    v_mfma_f32_16x16x32_bf16 v[128:131], v[124:127], v[36:39], v[128:131]
    s_waitcnt lgkmcnt(4)
    v_mfma_f32_16x16x32_bf16 v[128:131], v[124:127], v[40:43], v[128:131]
    s_waitcnt lgkmcnt(3)
    v_mfma_f32_16x16x32_bf16 v[128:131], v[124:127], v[44:47], v[128:131]
    s_waitcnt lgkmcnt(2)
    v_mfma_f32_16x16x32_bf16 v[128:131], v[124:127], v[48:51], v[128:131]
    s_waitcnt lgkmcnt(1)
    v_mfma_f32_16x16x32_bf16 v[128:131], v[124:127], v[52:55], v[128:131]
    s_waitcnt lgkmcnt(0)
    v_mfma_f32_16x16x32_bf16 v[128:131], v[124:127], v[56:59], v[128:131]
    s_setprio 0
    s_nop 6
    v_add_f32_dpp v164, v128, v128 row_ror:8 row_mask:0xf bank_mask:0xf
    v_mov_b32 v165, s63
    v_add_f32_dpp v166, v129, v129 row_ror:8 row_mask:0xf bank_mask:0xf
    v_mov_b32 v167, s63
    v_add_f32_dpp v168, v130, v130 row_ror:8 row_mask:0xf bank_mask:0xf
    v_mov_b32 v169, s63
    v_add_f32_dpp v170, v131, v131 row_ror:8 row_mask:0xf bank_mask:0xf
    v_mov_b32 v171, s63
    s_mov_b64 exec, 0x00ff00ff
    buffer_store_dwordx4 v[164:167], v173, s[32:35], s54 offen offset:0 sc1
    buffer_store_dwordx4 v[168:171], v173, s[32:35], s54 offen offset:256 sc1
    s_mov_b64 exec, -1
    s_setpc_b64 s[52:53]
L_publish:
    buffer_store_dwordx4 v[132:135], v2, s[32:35], s44 offen offset:0 sc1
    buffer_store_dwordx4 v[136:139], v2, s[32:35], s44 offen offset:1024 sc1
    buffer_store_dwordx4 v[140:143], v2, s[32:35], s44 offen offset:2048 sc1
    buffer_store_dwordx4 v[144:147], v2, s[32:35], s44 offen offset:3072 sc1
    buffer_store_dwordx4 v[148:151], v2, s[32:35], s45 offen offset:0 sc1
    buffer_store_dwordx4 v[152:155], v2, s[32:35], s45 offen offset:1024 sc1
    buffer_store_dwordx4 v[156:159], v2, s[32:35], s45 offen offset:2048 sc1
    buffer_store_dwordx4 v[160:163], v2, s[32:35], s45 offen offset:3072 sc1
    s_waitcnt vmcnt(0)
L_arrive:
    v_mov_b32 v218, 129280
    v_mov_b32 v219, 1
    s_mov_b64 exec, 1
    ds_add_rtn_u32 v219, v218, v219
    s_waitcnt lgkmcnt(0)
    v_cmp_eq_u32 vcc, 3, v219
    s_cbranch_vccz L_notlast27
    s_mov_b64 exec, 0xffff
    v_mov_b32 v218, s63
    buffer_store_dword v218, v252, s[32:35], s47 offen sc1
L_notlast27:
    s_mov_b64 exec, -1
    s_setpc_b64 s[52:53]
L_list:
    s_waitcnt lgkmcnt(0)
    s_mov_b32 s49, 0
    s_cmp_eq_u32 s19, s63
    s_addc_u32 s49, s49, s49
    s_cmp_eq_u32 s18, s63
    s_addc_u32 s49, s49, s49
    s_cmp_eq_u32 s17, s63
    s_addc_u32 s49, s49, s49
    s_cmp_eq_u32 s16, s63
    s_addc_u32 s49, s49, s49
    s_cmp_eq_u32 s15, s63
    s_addc_u32 s49, s49, s49
    s_cmp_eq_u32 s14, s63
    s_addc_u32 s49, s49, s49
    s_cmp_eq_u32 s13, s63
    s_addc_u32 s49, s49, s49
    s_cmp_eq_u32 s12, s63
    s_addc_u32 s49, s49, s49
    s_cmp_eq_u32 s11, s63
    s_addc_u32 s49, s49, s49
    s_cmp_eq_u32 s10, s63
    s_addc_u32 s49, s49, s49
    s_cmp_eq_u32 s9, s63
    s_addc_u32 s49, s49, s49
    s_cmp_eq_u32 s8, s63
    s_addc_u32 s49, s49, s49
    s_cmp_eq_u32 s7, s63
    s_addc_u32 s49, s49, s49
    s_cmp_eq_u32 s6, s63
    s_addc_u32 s49, s49, s49
    s_cmp_eq_u32 s5, s63
    s_addc_u32 s49, s49, s49
    s_cmp_eq_u32 s4, s63
    s_addc_u32 s49, s49, s49
    s_load_dwordx16 s[4:19], s[78:79], 0 glc
    s_sub_u32 s22, s22, 1
    s_cselect_b32 s49, 0xffff, s49
    s_andn2_b32 s49, s49, s48
    s_cbranch_scc0 L_ld29
    s_or_b32 s48, s48, s49
L_li28:
    s_ff1_i32_b32 s85, s49
    s_bitset0_b32 s49, s85
    s_lshl_b32 s85, s85, 14
    v_mov_b32 v218, s23
    v_mov_b32 v219, s85
    ds_write_b32 v218, v219
    s_sub_u32 s23, s23, 4
    s_cmp_lg_u32 s49, 0
    s_cbranch_scc1 L_li28
L_ld29:
    s_setpc_b64 s[54:55]
L_codeend:
.section .rodata,"a"
.p2align 6
.amdhsa_kernel parallel_sum__mha_block__moe_arch_mod__prompt_kernel
  .amdhsa_next_free_vgpr 256
  .amdhsa_next_free_sgpr 102
  .amdhsa_accum_offset 256
  .amdhsa_group_segment_fixed_size 0
  .amdhsa_kernarg_size 88
  .amdhsa_user_sgpr_count 2
  .amdhsa_user_sgpr_kernarg_segment_ptr 1
  .amdhsa_system_sgpr_workgroup_id_x 1
  .amdhsa_float_denorm_mode_32 3
.end_amdhsa_kernel
```
